```python
import torch

def _softmax(x, axis=-1):
    return torch.softmax(x, dim=axis)
def _gelu(x):
    return torch.nn.functional.gelu(x, approximate="tanh")
def _silu(x):
    return torch.nn.functional.silu(x)
def _sigmoid(x):
    return torch.sigmoid(x)
def _layernorm(x, axis=-1, eps=1e-5):
    m = x.mean(dim=axis, keepdim=True)
    v = x.var(dim=axis, keepdim=True, unbiased=False)
    return (x - m) / torch.sqrt(v + eps)
def _scatter_add(tgt, idx, src, axis=0):
    return tgt.clone().index_add_(axis, idx, src)
def _segment_sum(src, seg, n):
    out = torch.zeros((n,) + src.shape[1:], dtype=src.dtype)
    return out.index_add_(0, seg, src)
def _pad(x, pw):
    flat = tuple(v for pair in reversed(pw) for v in pair)
    return torch.nn.functional.pad(x, flat)

kernel_name = 'interleave_layers__sliding_block_cached__mixer_channel_mlp__decode'

def setup_inputs():

    _w = (lambda a: (lambda t: t.to(torch.bfloat16) if t.is_floating_point() else t)(torch.as_tensor(a)))
    def _A_setup():
        B, Sq, D = 8, 1, 1024
        Hq, Hkv, Sk, Dh = 32, 4, 4096, 128
        assert Hq % Hkv == 0, (Hq, Hkv)
        return {
            "x": _w((lambda *s: torch.randn(*s, dtype=torch.bfloat16) * 0.05)(B, Sq, D)),
            "k_cache": _w((lambda *s: torch.randn(*s, dtype=torch.bfloat16) * 1.6)(B, Hkv, Sk, Dh)),
            "v_cache": _w((lambda *s: torch.randn(*s, dtype=torch.bfloat16) * 1.6)(B, Hkv, Sk, Dh)),
            "wq": _w((lambda *s: torch.randn(*s, dtype=torch.bfloat16) * 1.6)(D, Hq * Dh) * (D ** -0.5)),
            "wo": _w((lambda *s: torch.randn(*s, dtype=torch.bfloat16) * 1.6)(Hq * Dh, D) * ((Hq * Dh) ** -0.5)),
        }
    _A_in = _A_setup()

    def _B_setup():
        B, S, D, F = 8, 1, 1024, 3584
        return {
            "x": _w((lambda *s: torch.randn(*s, dtype=torch.bfloat16) * 0.05)(B, S, D)),
            "w1": _w((lambda *s: torch.randn(*s, dtype=torch.bfloat16) * 3.2)(D, F) * (D ** -0.5)),
            "b1": _w((lambda *s: torch.randn(*s, dtype=torch.bfloat16) * 0.8)(F)),
            "w2": _w((lambda *s: torch.randn(*s, dtype=torch.bfloat16) * 0.4)(F, D) * (F ** -0.5)),
            "b2": _w((lambda *s: torch.randn(*s, dtype=torch.bfloat16) * 0.4)(D)),
        }
    _B_in = _B_setup()

    return {
        "A_x": _A_in["x"],
        "A_k_cache": _A_in["k_cache"],
        "A_v_cache": _A_in["v_cache"],
        "A_wq": _A_in["wq"],
        "A_wo": _A_in["wo"],
        "B_x": _B_in["x"],
        "B_w1": _B_in["w1"],
        "B_b1": _B_in["b1"],
        "B_w2": _B_in["w2"],
        "B_b2": _B_in["b2"],
    }

def reference(A_x, A_k_cache, A_v_cache, A_wq, A_wo, B_x, B_w1, B_b1, B_w2, B_b2):
    def _A_ref(x, k_cache, v_cache, wq, wo):
        B, Sq, D = x.shape
        Hq, Dh = 32, 128
        Hkv, Sk = k_cache.shape[1], k_cache.shape[2]
        W = min(4096, max(256, Sk // 4))
        rep = Hq // Hkv
        q = (lambda x, *d: x.permute(*d))((x @ wq).reshape(B, Sq, Hq, Dh), 0, 2, 1, 3)
        k = (lambda x, n, axis: torch.repeat_interleave(x, n, dim=axis))(k_cache[:, :, Sk - W:, :], rep, axis=1)
        v = (lambda x, n, axis: torch.repeat_interleave(x, n, dim=axis))(v_cache[:, :, Sk - W:, :], rep, axis=1)
        scores = torch.einsum("bhqd,bhkd->bhqk", q, k) * (Dh ** -0.5)
        p = _softmax(scores, axis=-1)
        o = torch.einsum("bhqk,bhkd->bhqd", p, v)
        return (lambda x, *d: x.permute(*d))(o, 0, 2, 1, 3).reshape(B, Sq, Hq * Dh) @ wo

    def _B_ref(x, w1, b1, w2, b2):
        y = _layernorm(x, axis=-1)
        h = _gelu(torch.einsum("bsd,df->bsf", y, w1) + b1)
        return torch.einsum("bsf,fd->bsd", h, w2) + b2

    x = A_x
    x = x + _A_ref(_layernorm(x, axis=-1), A_k_cache, A_v_cache, A_wq, A_wo)
    x = x + _B_ref(_layernorm(x, axis=-1), B_w1, B_b1, B_w2, B_b2)
    x = x + _A_ref(_layernorm(x, axis=-1), A_k_cache, A_v_cache, A_wq, A_wo)
    x = x + _B_ref(_layernorm(x, axis=-1), B_w1, B_b1, B_w2, B_b2)
    return x
```

```asm
; @launch grid=(256,1,1) block=(384,1,1) lds=163840
.amdgcn_target "amdgcn-amd-amdhsa--gfx950"
.text
.globl interleave_layers__sliding_block_cached__mixer_channel_mlp__decode_kernel
.p2align 8
.type interleave_layers__sliding_block_cached__mixer_channel_mlp__decode_kernel,@function
interleave_layers__sliding_block_cached__mixer_channel_mlp__decode_kernel:
    s_cmp_ge_u32 s2, 256
    s_cbranch_scc1 L_end
    s_load_dwordx16 s[4:19], s[0:1], 0
    s_load_dwordx8 s[20:27], s[0:1], 64
    s_load_dwordx2 s[28:29], s[0:1], 96
    v_lshrrev_b32 v1, 6, v0
    v_and_b32 v0, 63, v0
    v_readfirstlane_b32 s35, v1
    s_and_b32 s3, s2, 7
    s_lshr_b32 s32, s2, 3
    s_lshr_b32 s33, s32, 3
    s_and_b32 s34, s32, 7
    s_mov_b32 s63, 0
    s_mov_b32 s65, 0
    v_mov_b32 v253, 154368
    v_mov_b32 v225, 1
    s_cmp_eq_u32 s35, 4
    s_cbranch_scc1 L_loader
    s_cmp_eq_u32 s35, 5
    s_cbranch_scc1 L_reducer
    s_setprio 2
    v_and_b32 v1, 15, v0
    v_lshrrev_b32 v2, 4, v0
    v_and_b32 v3, 7, v0
    v_bfe_u32 v5, v0, 3, 1
    v_lshrrev_b32 v6, 5, v0
    v_and_b32 v7, 31, v0
    v_bfe_u32 v8, v0, 2, 2
    v_and_b32 v12, 3, v0
    s_lshl_b32 s44, s3, 8
    v_lshl_add_u32 v13, v1, 11, s44
    v_lshl_add_u32 v13, v2, 3, v13
    v_cmp_eq_u32 vcc, 8, v1
    v_mov_b32 v9, 0
    v_mov_b32 v10, 0x3f803f80
    v_cndmask_b32 v9, v9, v10, vcc
    v_mov_b32 v16, v9
    v_mov_b32 v17, v9
    v_mov_b32 v18, v9
    v_mov_b32 v19, v9
    v_mov_b32 v20, v9
    v_mov_b32 v21, v9
    v_mov_b32 v22, v9
    v_mov_b32 v23, v9
    v_mov_b32 v24, v9
    v_mov_b32 v25, v9
    v_mov_b32 v26, v9
    v_mov_b32 v27, v9
    v_mov_b32 v28, v9
    v_mov_b32 v29, v9
    v_mov_b32 v30, v9
    v_mov_b32 v31, v9
    s_waitcnt lgkmcnt(0)
    s_mov_b32 exec_lo, 0xff00ff
    s_mov_b32 exec_hi, 0xff00ff
    global_load_dwordx2 v[16:17], v13, s[4:5] offset:0
    global_load_dwordx2 v[18:19], v13, s[4:5] offset:32
    global_load_dwordx2 v[20:21], v13, s[4:5] offset:64
    global_load_dwordx2 v[22:23], v13, s[4:5] offset:96
    global_load_dwordx2 v[24:25], v13, s[4:5] offset:128
    global_load_dwordx2 v[26:27], v13, s[4:5] offset:160
    global_load_dwordx2 v[28:29], v13, s[4:5] offset:192
    global_load_dwordx2 v[30:31], v13, s[4:5] offset:224
    s_mov_b64 exec, -1
    s_add_u32 s46, s28, 0x541000
    s_addc_u32 s47, s29, 0
    s_load_dword s62, s[46:47], 0
    s_mov_b32 s30, s28
    s_mov_b32 s31, s29
    s_barrier
    s_lshl_b32 s44, s33, 14
    s_lshl_b32 s45, s34, 11
    s_add_u32 s44, s44, s45
    s_lshl_b32 s45, s3, 8
    s_add_u32 s44, s44, s45
    s_lshl_b32 s45, s35, 6
    s_add_u32 s44, s44, s45
    s_add_u32 s44, s44, 0x500000
    v_lshl_add_u32 v120, v1, 2, s44
    v_and_b32 v9, 1, v2
    v_add_u32 v227, 0xffb00000, v120
    v_lshl_add_u32 v227, v9, 18, v227
    v_lshl_add_u32 v227, v6, 17, v227
    v_add_u32 v228, 0x10000, v227
    v_lshrrev_b32 v9, 2, v0
    v_lshlrev_b32 v9, 8, v9
    v_lshrrev_b32 v10, 1, v12
    v_lshl_add_u32 v9, v10, 4, v9
    v_and_b32 v10, 1, v12
    v_lshl_add_u32 v9, v10, 3, v9
    v_xor_b32 v10, s35, v8
    v_lshl_add_u32 v240, v10, 6, v9
    s_lshl_b32 s44, s35, 13
    s_add_u32 s44, s44, 65536
    v_add_u32 v9, s44, v9
    v_lshl_add_u32 v241, v8, 6, v9
    s_lshl_b32 s44, s33, 17
    s_lshl_b32 s45, s35, 15
    s_add_u32 s44, s44, s45
    s_lshl_b32 s45, s3, 11
    s_add_u32 s44, s44, s45
    s_lshl_b32 s45, s34, 8
    s_add_u32 s44, s44, s45
    s_add_u32 s44, s44, 0x80000
    v_lshl_add_u32 v232, v6, 14, s44
    v_lshl_add_u32 v232, v7, 3, v232
    s_lshl_b32 s44, s33, 13
    s_lshl_b32 s45, s3, 10
    s_add_u32 s44, s44, s45
    s_lshl_b32 s45, s34, 7
    s_add_u32 s44, s44, s45
    s_lshl_b32 s45, s35, 4
    s_add_u32 s44, s44, s45
    s_add_u32 s44, s44, 0x180000
    v_lshl_add_u32 v233, v6, 3, s44
    s_lshl_b32 s44, s32, 14
    s_lshl_b32 s45, s35, 12
    s_add_u32 s44, s44, s45
    s_lshl_b32 s45, s3, 9
    s_add_u32 s44, s44, s45
    s_add_u32 s44, s44, 0x100000
    v_lshl_add_u32 v238, v2, 7, s44
    v_lshl_add_u32 v238, v1, 4, v238
    v_and_b32 v9, 1, v2
    s_lshl_b32 s44, s32, 8
    s_lshl_b32 s45, s35, 6
    s_add_u32 s44, s44, s45
    v_lshl_add_u32 v13, v9, 5, s44
    v_lshl_add_u32 v13, v6, 4, v13
    v_lshl_add_u32 v13, v5, 3, v13
    s_cmp_lt_u32 s32, 28
    s_cbranch_scc1 e_1
er_2:
    s_lshl_b32 s44, s35, 2
    v_lshl_add_u32 v10, v6, 1, s44
    v_add_u32 v10, v10, v5
    v_lshlrev_b32 v11, 3, v9
    v_xor_b32 v14, v3, v10
    v_and_b32 v14, 7, v14
    v_lshlrev_b32 v248, 7, v10
    v_lshl_add_u32 v248, v14, 4, v248
    v_add_u32 v248, v11, v248
    v_add_u32 v248, 135168, v248
    v_and_b32 v10, 12, v1
    v_add_u32 v10, v10, v9
    v_and_b32 v11, 1, v1
    v_lshl_add_u32 v10, v11, 1, v10
    s_lshl_b32 s44, s35, 1
    v_add_u32 v68, s44, v6
    v_bfe_u32 v11, v1, 1, 1
    v_lshlrev_b32 v69, 3, v11
    v_xor_b32 v14, v68, v10
    v_and_b32 v14, 7, v14
    v_lshlrev_b32 v247, 7, v10
    v_lshl_add_u32 v247, v14, 4, v247
    v_add_u32 v247, v69, v247
    v_add_u32 v247, 133120, v247
    v_and_b32 v10, 12, v1
    v_add_u32 v10, v10, v11
    v_and_b32 v11, 1, v1
    v_lshlrev_b32 v11, 3, v11
    v_lshl_add_u32 v11, v9, 2, v11
    v_xor_b32 v14, v68, v10
    v_and_b32 v14, 7, v14
    v_lshlrev_b32 v243, 7, v10
    v_lshl_add_u32 v243, v14, 4, v243
    v_add_u32 v243, v11, v243
    v_add_u32 v243, 131072, v243
    v_add_u32 v10, 2, v10
    v_xor_b32 v14, v68, v10
    v_and_b32 v14, 7, v14
    v_lshlrev_b32 v244, 7, v10
    v_lshl_add_u32 v244, v14, 4, v244
    v_add_u32 v244, v11, v244
    v_add_u32 v244, 131072, v244
    v_xor_b32 v14, v3, v2
    v_and_b32 v14, 7, v14
    v_lshlrev_b32 v245, 7, v2
    v_lshl_add_u32 v245, v14, 4, v245
    v_add_u32 v245, 131072, v245
    v_xor_b32 v246, 64, v245
    s_lshl_b32 s44, s33, 14
    s_lshl_b32 s45, s35, 12
    s_add_u32 s44, s44, s45
    s_add_u32 s44, s44, 0x500000
    v_lshl_add_u32 v121, v0, 4, s44
    s_lshl_b32 s44, s3, 16
    s_lshl_b32 s45, s33, 14
    s_add_u32 s44, s44, s45
    s_lshl_b32 s45, s35, 12
    s_add_u32 s44, s44, s45
    v_lshl_add_u32 v229, v0, 4, s44
    v_lshrrev_b32 v9, 3, v0
    s_lshl_b32 s44, s3, 4
    s_add_u32 s44, s44, 0x188400
    v_lshl_add_u32 v230, v9, 7, s44
    s_mov_b32 s44, 0x188000
    v_lshl_add_u32 v231, v0, 4, s44
    s_lshl_b32 s44, s33, 13
    s_lshl_b32 s45, s35, 11
    s_add_u32 s44, s44, s45
    s_lshl_b32 s45, s34, 3
    s_add_u32 s44, s44, s45
    s_add_u32 s44, s44, 0x180000
    v_lshl_add_u32 v234, v2, 7, s44
    v_lshl_add_u32 v234, v5, 10, v234
    s_lshl_b32 s44, s32, 14
    s_lshl_b32 s45, s35, 12
    s_add_u32 s44, s44, s45
    s_add_u32 s44, s44, 0x80000
    v_lshl_add_u32 v235, v0, 4, s44
    s_lshl_b32 s44, s3, 17
    s_lshl_b32 s45, s35, 15
    s_add_u32 s44, s44, s45
    s_lshl_b32 s45, s32, 7
    s_add_u32 s44, s44, s45
    s_add_u32 s44, s44, 0x400000
    v_lshl_add_u32 v236, v5, 14, s44
    v_lshl_add_u32 v236, v2, 12, v236
    v_lshl_add_u32 v236, v3, 4, v236
    s_lshl_b32 s44, s3, 11
    s_add_u32 s44, s44, 0x18c000
    v_lshl_add_u32 v237, v2, 7, s44
    v_lshl_add_u32 v237, v1, 4, v237
    s_lshl_b32 s44, s32, 14
    s_lshl_b32 s45, s35, 12
    s_add_u32 s44, s44, s45
    s_add_u32 s44, s44, 0x100000
    v_lshl_add_u32 v239, v2, 9, s44
    v_lshl_add_u32 v239, v1, 4, v239
    s_lshl_b32 s44, s32, 12
    s_lshl_b32 s45, s35, 10
    s_add_u32 s44, s44, s45
    s_lshl_b32 s45, s3, 7
    s_add_u32 s44, s44, s45
    s_add_u32 s44, s44, 0x520000
    v_lshl_add_u32 v122, v2, 4, s44
    s_mul_i32 s44, s35, 4224
    s_add_u32 s44, s44, 0x21800
    v_mov_b32 v249, s44
    s_mov_b32 s45, 528
    v_mad_u32_u24 v249, v3, s45, v249
    v_lshl_add_u32 v249, v5, 6, v249
    v_lshl_add_u32 v249, v2, 4, v249
    s_mul_i32 s44, s35, 1056
    s_add_u32 s44, s44, 0x21800
    v_mov_b32 v250, s44
    s_mov_b32 s45, 528
    v_mad_u32_u24 v250, v6, s45, v250
    v_lshl_add_u32 v250, v7, 4, v250
    s_lshl_b32 s44, s35, 3
    s_add_u32 s44, s44, 0x25a00
    v_lshl_add_u32 v251, v1, 5, s44
    s_lshl_b32 s44, s35, 6
    s_add_u32 s44, s44, 0x25a00
    v_lshl_add_u32 v252, v6, 5, s44
    s_lshl_b32 s44, s33, 13
    s_lshl_b32 s45, s3, 10
    s_add_u32 s44, s44, s45
    s_lshl_b32 s45, s34, 7
    s_add_u32 s44, s44, s45
    s_add_u32 s44, s44, 0x194000
    v_mov_b32 v242, s44
    v_and_b32 v9, 1, v1
    v_lshlrev_b32 v9, 4, v9
    v_mov_b32 v10, 0xffff
    v_lshlrev_b32 v10, v9, v10
    v_lshrrev_b32 v9, 1, v3
    v_cmp_eq_u32 s[56:57], 1, v5
    v_cmp_eq_u32 s[58:59], 1, v6
    v_cmp_eq_u32 vcc, 0, v9
    s_nop 1
    v_cndmask_b32 v108, 0, v10, vcc
    v_and_b32 v11, 0x3f803f80, v108
    v_cndmask_b32 v100, v11, 0, s[56:57]
    v_cndmask_b32 v104, 0, v11, s[56:57]
    v_cmp_eq_u32 vcc, 1, v9
    s_nop 1
    v_cndmask_b32 v109, 0, v10, vcc
    v_and_b32 v11, 0x3f803f80, v109
    v_cndmask_b32 v101, v11, 0, s[56:57]
    v_cndmask_b32 v105, 0, v11, s[56:57]
    v_cmp_eq_u32 vcc, 2, v9
    s_nop 1
    v_cndmask_b32 v110, 0, v10, vcc
    v_and_b32 v11, 0x3f803f80, v110
    v_cndmask_b32 v102, v11, 0, s[56:57]
    v_cndmask_b32 v106, 0, v11, s[56:57]
    v_cmp_eq_u32 vcc, 3, v9
    s_nop 1
    v_cndmask_b32 v111, 0, v10, vcc
    v_and_b32 v11, 0x3f803f80, v111
    v_cndmask_b32 v103, v11, 0, s[56:57]
    v_cndmask_b32 v107, 0, v11, s[56:57]
    s_xor_b64 s[60:61], s[56:57], s[58:59]
    v_and_b32 v9, 1, v0
    v_cmp_eq_u32 s[54:55], 1, v9
    s_mov_b32 s70, 0x3e0293ee
    s_mov_b32 s71, 0x3727c5ac
    s_mov_b32 s72, 0x3a800000
    s_mov_b32 s73, 0xbdd2d3e8
    s_cmp_eq_u32 s35, 0
    s_cselect_b32 s68, 1, 0
    s_mov_b32 s69, 0
    s_lshl_b32 s44, s35, 13
    s_add_u32 s44, s44, 32768
    v_lshlrev_b32 v9, 8, v1
    v_lshl_add_u32 v9, v2, 4, v9
    v_add_u32 v9, s44, v9
    v_xor_b32 v10, 0, v12
    v_lshl_add_u32 v112, v10, 6, v9
    v_xor_b32 v10, 1, v12
    v_lshl_add_u32 v113, v10, 6, v9
    v_xor_b32 v10, 2, v12
    v_lshl_add_u32 v114, v10, 6, v9
    v_xor_b32 v10, 3, v12
    v_lshl_add_u32 v115, v10, 6, v9
    v_mov_b32 v15, 0xff
    s_mov_b32 s66, 0
    s_mov_b32 s67, 4
    s_waitcnt lgkmcnt(0)
    s_add_u32 s44, s62, 1
    s_lshl_b32 s44, s44, 3
    s_and_b32 s44, s44, 0xff
    s_xor_b32 s36, s44, 0x0
    s_xor_b32 s37, s44, 0x55
    s_xor_b32 s38, s44, 0xa3
    s_xor_b32 s39, s44, 0xce
    s_xor_b32 s40, s36, 1
    s_xor_b32 s41, s37, 1
    s_xor_b32 s42, s38, 1
    s_xor_b32 s43, s39, 1
    s_xor_b32 s74, s62, 0x2545f491
    s_mul_i32 s74, s74, 0x9e3779b1
    s_add_u32 s74, s74, 0x632be5ab
lw_3:
    ds_read_b32 v4, v253 offset:28
    s_waitcnt lgkmcnt(0)
    v_cmp_gt_u32 vcc, 1, v4
    s_cbranch_vccnz rt_4
lw_5:
    ds_read_b32 v4, v253 offset:64
    s_waitcnt lgkmcnt(0)
    v_cmp_gt_u32 vcc, 1, v4
    s_cbranch_vccnz rt_6
    ds_read_b64_tr_b16 v[128:129], v240 offset:0
    ds_read_b64_tr_b16 v[130:131], v240 offset:4096
    ds_read_b64_tr_b16 v[144:145], v240 offset:32
    ds_read_b64_tr_b16 v[146:147], v240 offset:4128
    ds_read_b64_tr_b16 v[132:133], v240 offset:8192
    ds_read_b64_tr_b16 v[134:135], v240 offset:12288
    ds_read_b64_tr_b16 v[148:149], v240 offset:8224
    ds_read_b64_tr_b16 v[150:151], v240 offset:12320
    ds_read_b64_tr_b16 v[136:137], v240 offset:16384
    ds_read_b64_tr_b16 v[138:139], v240 offset:20480
    ds_read_b64_tr_b16 v[152:153], v240 offset:16416
    ds_read_b64_tr_b16 v[154:155], v240 offset:20512
    ds_read_b64_tr_b16 v[140:141], v240 offset:24576
    ds_read_b64_tr_b16 v[142:143], v240 offset:28672
    ds_read_b64_tr_b16 v[156:157], v240 offset:24608
    ds_read_b64_tr_b16 v[158:159], v240 offset:28704
    s_waitcnt vmcnt(0) lgkmcnt(0)
.p2align 6
L_layer:
    v_mfma_f32_16x16x32_bf16 v[32:35], v[16:19], v[128:131], 0
    v_mfma_f32_16x16x32_bf16 v[36:39], v[16:19], v[144:147], 0
    s_mov_b64 exec, 1
    ds_add_u32 v253, v225 offset:52
    s_mov_b64 exec, -1
    v_mfma_f32_16x16x32_bf16 v[32:35], v[20:23], v[132:135], v[32:35]
    v_mfma_f32_16x16x32_bf16 v[36:39], v[20:23], v[148:151], v[36:39]
    v_mfma_f32_16x16x32_bf16 v[32:35], v[24:27], v[136:139], v[32:35]
    v_mfma_f32_16x16x32_bf16 v[36:39], v[24:27], v[152:155], v[36:39]
    v_mfma_f32_16x16x32_bf16 v[32:35], v[28:31], v[140:143], v[32:35]
    v_mfma_f32_16x16x32_bf16 v[36:39], v[28:31], v[156:159], v[36:39]
    s_nop 7
    v_cvt_pk_bf16_f32 v68, v32, v36
    v_cvt_pk_bf16_f32 v69, v33, v37
    v_cvt_pk_bf16_f32 v70, v34, v38
    v_cvt_pk_bf16_f32 v71, v35, v39
    v_min_u32 v68, -2, v68
    v_min_u32 v69, -2, v69
    v_min_u32 v70, -2, v70
    v_min_u32 v71, -2, v71
    s_cmp_eq_u32 s63, 0
    s_cbranch_scc1 l0_7
l0r_8:
    v_permlane32_swap_b32 v68, v70
    v_permlane32_swap_b32 v69, v71
    global_store_dword v227, v68, s[30:31] sc1
    global_store_dword v228, v69, s[30:31] sc1
    s_cmp_eq_u32 s63, 0
    s_cbranch_scc1 l0q_9
    v_xor_b32 v12, 64, v241
    v_xor_b32 v13, 128, v241
    v_xor_b32 v14, 192, v241
    ds_read_b64_tr_b16 v[192:193], v241 offset:0
    ds_read_b64_tr_b16 v[194:195], v241 offset:4096
    ds_read_b64_tr_b16 v[196:197], v241 offset:32
    ds_read_b64_tr_b16 v[198:199], v241 offset:4128
    ds_read_b64_tr_b16 v[200:201], v12 offset:0
    ds_read_b64_tr_b16 v[202:203], v12 offset:4096
    ds_read_b64_tr_b16 v[204:205], v12 offset:32
    ds_read_b64_tr_b16 v[206:207], v12 offset:4128
    ds_read_b64_tr_b16 v[208:209], v13 offset:0
    ds_read_b64_tr_b16 v[210:211], v13 offset:4096
    ds_read_b64_tr_b16 v[212:213], v13 offset:32
    ds_read_b64_tr_b16 v[214:215], v13 offset:4128
    ds_read_b64_tr_b16 v[216:217], v14 offset:0
    ds_read_b64_tr_b16 v[218:219], v14 offset:4096
    ds_read_b64_tr_b16 v[220:221], v14 offset:32
    ds_read_b64_tr_b16 v[222:223], v14 offset:4128
    s_mov_b32 s66, 1
    s_barrier
L_e1:
    global_load_dwordx4 v[68:71], v229, s[30:31] offset:0 sc1
    global_load_dwordx4 v[72:75], v229, s[30:31] offset:1024 sc1
    global_load_dwordx4 v[76:79], v229, s[30:31] offset:2048 sc1
    global_load_dwordx4 v[80:83], v229, s[30:31] offset:3072 sc1
    global_load_dwordx4 v[56:59], v230, s[30:31] sc1
L_e1p:
    s_waitcnt vmcnt(4)
    v_mfma_f32_16x16x32_bf16 v[64:67], v[100:103], v[68:71], 0
    v_max3_u32 v1, v68, v69, v70
    v_max_u32 v1, v1, v71
    s_waitcnt vmcnt(3)
    v_mfma_f32_16x16x32_bf16 v[64:67], v[100:103], v[72:75], v[64:67]
    v_max3_u32 v1, v1, v72, v73
    v_max3_u32 v1, v1, v74, v75
    s_waitcnt vmcnt(2)
    v_mfma_f32_16x16x32_bf16 v[64:67], v[104:107], v[76:79], v[64:67]
    v_max3_u32 v1, v1, v76, v77
    v_max3_u32 v1, v1, v78, v79
    s_waitcnt vmcnt(1)
    v_mfma_f32_16x16x32_bf16 v[64:67], v[104:107], v[80:83], v[64:67]
    v_max3_u32 v1, v1, v80, v81
    v_max3_u32 v1, v1, v82, v83
    v_cmp_eq_u32 vcc, -1, v1
    s_nop 4
    v_cvt_pk_bf16_f32 v2, v64, v66
    v_cvt_pk_bf16_f32 v3, v65, v67
    s_cbranch_vccnz rt_10
    ds_write_b32 v243, v2 offset:0
    ds_write_b32 v244, v3 offset:0
    s_mov_b64 exec, 1
    ds_add_u32 v253, v225 offset:0
    s_mov_b64 exec, -1
fs_11:
    ds_read_b32 v4, v253 offset:0
    ds_read_b128 v[84:87], v245 offset:0
    ds_read_b128 v[88:91], v246 offset:512
    ds_read_b128 v[92:95], v245 offset:1024
    ds_read_b128 v[96:99], v246 offset:1536
    s_waitcnt vmcnt(0)
    v_add_f32_dpp v11, v58, v58 row_ror:8 row_mask:0xf bank_mask:0xf
    v_add_f32_dpp v9, v56, v56 row_ror:8 row_mask:0xf bank_mask:0xf
    v_xor_b32 v2, s74, v57
    v_mov_b32 v13, v11
    v_mov_b32 v14, v9
    v_bitop3_b32 v2, v2, v59, s74 bitop3:0xf6
    v_permlane16_swap_b32 v11, v13
    v_permlane16_swap_b32 v9, v14
    v_add_f32 v11, v11, v13
    v_add_f32 v9, v9, v14
    v_mov_b32 v13, v11
    v_mov_b32 v14, v9
    v_cmp_ne_u32 s[46:47], 0, v2
    v_permlane32_swap_b32 v11, v13
    v_permlane32_swap_b32 v9, v14
    v_add_f32 v11, v11, v13
    v_add_f32 v9, v9, v14
    s_waitcnt lgkmcnt(4)
    v_cmp_gt_u32 vcc, s67, v4
    v_mul_f32 v11, s72, v11
    v_mul_f32 v9, s72, v9
    v_fma_f32 v9, -v11, v11, v9
    v_max_f32 v9, 0, v9
    s_cbranch_vccnz fsr_12
    s_waitcnt lgkmcnt(3)
    v_mfma_f32_16x16x32_bf16 v[32:35], v[160:163], v[84:87], 0
    v_add_f32 v9, s71, v9
    v_rsq_f32 v9, v9
    v_mfma_f32_16x16x32_bf16 v[36:39], v[176:179], v[84:87], 0
    s_waitcnt lgkmcnt(2)
    v_mfma_f32_16x16x32_bf16 v[32:35], v[164:167], v[88:91], v[32:35]
    v_mul_f32 v9, s70, v9
    v_mfma_f32_16x16x32_bf16 v[36:39], v[180:183], v[88:91], v[36:39]
    s_waitcnt lgkmcnt(1)
    v_mfma_f32_16x16x32_bf16 v[32:35], v[168:171], v[92:95], v[32:35]
    v_mfma_f32_16x16x32_bf16 v[36:39], v[184:187], v[92:95], v[36:39]
    s_waitcnt lgkmcnt(0)
    v_mfma_f32_16x16x32_bf16 v[32:35], v[172:175], v[96:99], v[32:35]
    v_mfma_f32_16x16x32_bf16 v[36:39], v[188:191], v[96:99], v[36:39]
    s_cmp_lg_u64 s[46:47], 0
    s_cbranch_scc1 sta_13
star_14:
    s_nop 4
    v_fma_f32 v68, -v11, v112, v32
    v_fma_f32 v69, -v11, v113, v33
    v_fma_f32 v70, -v11, v114, v34
    v_fma_f32 v71, -v11, v115, v35
    v_fma_f32 v72, -v11, v116, v36
    v_fma_f32 v73, -v11, v117, v37
    v_fma_f32 v74, -v11, v118, v38
    v_fma_f32 v75, -v11, v119, v39
    v_max3_f32 v1, v68, v69, v70
    v_max3_f32 v3, v71, v72, v73
    v_max3_f32 v1, v1, v74, v75
    v_max_f32 v1, v1, v3
    v_mov_b32 v3, v1
    v_mov_b32 v84, 0x3f803f80
    v_mov_b32 v85, 0x3f803f80
    v_permlane16_swap_b32 v1, v3
    v_max_f32 v1, v1, v3
    v_mov_b32 v3, v1
    v_mov_b32 v86, 0x3f803f80
    v_mov_b32 v87, 0x3f803f80
    v_permlane32_swap_b32 v1, v3
    v_max_f32 v1, v1, v3
    v_mul_f32 v76, v9, v1
    v_fma_f32 v68, v68, v9, -v76
    v_fma_f32 v69, v69, v9, -v76
    v_fma_f32 v70, v70, v9, -v76
    v_fma_f32 v71, v71, v9, -v76
    v_fma_f32 v72, v72, v9, -v76
    v_fma_f32 v73, v73, v9, -v76
    v_fma_f32 v74, v74, v9, -v76
    v_fma_f32 v75, v75, v9, -v76
    v_exp_f32 v68, v68
    v_exp_f32 v69, v69
    v_exp_f32 v70, v70
    v_exp_f32 v71, v71
    v_exp_f32 v72, v72
    v_exp_f32 v73, v73
    v_exp_f32 v74, v74
    v_exp_f32 v75, v75
    v_mov_b32 v5, s74
    v_cvt_pk_bf16_f32 v80, v68, v69
    v_cvt_pk_bf16_f32 v81, v70, v71
    v_cvt_pk_bf16_f32 v82, v72, v73
    v_cvt_pk_bf16_f32 v83, v74, v75
    s_cmp_eq_u32 s66, 0
    s_cbranch_scc1 v_15
vr_16:
    v_mfma_f32_16x16x32_bf16 v[32:35], v[192:195], v[80:83], 0
    v_mfma_f32_16x16x32_bf16 v[36:39], v[196:199], v[80:83], 0
    v_mfma_f32_16x16x32_bf16 v[40:43], v[200:203], v[80:83], 0
    v_mfma_f32_16x16x32_bf16 v[44:47], v[204:207], v[80:83], 0
    s_mov_b64 exec, s[68:69]
    global_store_dword v242, v5, s[30:31] sc1
    s_mov_b64 exec, -1
    v_mfma_f32_16x16x32_bf16 v[64:67], v[84:87], v[80:83], 0
    v_mfma_f32_16x16x32_bf16 v[48:51], v[208:211], v[80:83], 0
    s_nop 0
    v_cndmask_b32 v32, v32, v36, s[56:57]
    v_cndmask_b32 v33, v33, v37, s[56:57]
    v_cndmask_b32 v34, v34, v38, s[56:57]
    v_cndmask_b32 v35, v35, v39, s[56:57]
    ds_write_b128 v249, v[32:35] offset:0
    v_mfma_f32_16x16x32_bf16 v[52:55], v[212:215], v[80:83], 0
    v_mfma_f32_16x16x32_bf16 v[56:59], v[216:219], v[80:83], 0
    v_cndmask_b32 v40, v40, v44, s[56:57]
    v_cndmask_b32 v41, v41, v45, s[56:57]
    v_cndmask_b32 v42, v42, v46, s[56:57]
    v_cndmask_b32 v43, v43, v47, s[56:57]
    ds_write_b128 v249, v[40:43] offset:128
    v_mfma_f32_16x16x32_bf16 v[60:63], v[220:223], v[80:83], 0
    v_mov_b32 v77, v64
    s_mov_b32 exec_lo, 0xff
    s_mov_b32 exec_hi, 0x0
    ds_write_b64 v251, v[76:77]
    s_mov_b64 exec, -1
    v_cndmask_b32 v48, v48, v52, s[56:57]
    v_cndmask_b32 v49, v49, v53, s[56:57]
    v_cndmask_b32 v50, v50, v54, s[56:57]
    v_cndmask_b32 v51, v51, v55, s[56:57]
    ds_write_b128 v249, v[48:51] offset:256
    v_cndmask_b32 v56, v56, v60, s[56:57]
    v_cndmask_b32 v57, v57, v61, s[56:57]
    v_cndmask_b32 v58, v58, v62, s[56:57]
    v_cndmask_b32 v59, v59, v63, s[56:57]
    ds_write_b128 v249, v[56:59] offset:384
    s_mov_b64 exec, 1
    ds_add_u32 v253, v225 offset:4
    s_mov_b64 exec, -1
fs_17:
    ds_read_b32 v4, v253 offset:4
    ds_read_b128 v[32:35], v252
    ds_read_b128 v[36:39], v252 offset:16
    ds_read_b128 v[68:71], v250 offset:0
    ds_read_b128 v[72:75], v250 offset:4224
    ds_read_b128 v[76:79], v250 offset:8448
    ds_read_b128 v[80:83], v250 offset:12672
    s_waitcnt lgkmcnt(4)
    v_cmp_gt_u32 vcc, s67, v4
    v_max3_f32 v2, v32, v34, v36
    v_max_f32 v2, v2, v38
    v_sub_f32 v32, v32, v2
    v_sub_f32 v34, v34, v2
    v_sub_f32 v36, v36, v2
    v_sub_f32 v38, v38, v2
    s_cbranch_vccnz fsr_18
    v_exp_f32 v32, v32
    v_exp_f32 v34, v34
    v_exp_f32 v36, v36
    v_exp_f32 v38, v38
    v_min_u32 v2, -2, v2
    v_mul_f32 v3, v32, v33
    v_fmac_f32 v3, v34, v35
    v_fmac_f32 v3, v36, v37
    v_fmac_f32 v3, v38, v39
    s_waitcnt lgkmcnt(3)
    v_pk_mul_f32 v[68:69], v[68:69], v[32:33] op_sel_hi:[1,0]
    v_pk_mul_f32 v[70:71], v[70:71], v[32:33] op_sel_hi:[1,0]
    s_waitcnt lgkmcnt(2)
    v_fmac_f32 v68, v72, v34
    v_fmac_f32 v69, v73, v34
    v_fmac_f32 v70, v74, v34
    v_fmac_f32 v71, v75, v34
    s_waitcnt lgkmcnt(1)
    v_fmac_f32 v68, v76, v36
    v_fmac_f32 v69, v77, v36
    v_fmac_f32 v70, v78, v36
    v_fmac_f32 v71, v79, v36
    s_waitcnt lgkmcnt(0)
    v_fmac_f32 v68, v80, v38
    v_fmac_f32 v69, v81, v38
    v_fmac_f32 v70, v82, v38
    v_fmac_f32 v71, v83, v38
    v_cvt_pk_bf16_f32 v68, v68, v69
    v_cvt_pk_bf16_f32 v69, v70, v71
    v_min_u32 v3, -2, v3
    v_min_u32 v68, -2, v68
    v_min_u32 v69, -2, v69
    global_store_dwordx2 v232, v[68:69], s[30:31] sc1
    s_mov_b32 exec_lo, 0x1
    s_mov_b32 exec_hi, 0x1
    global_store_dwordx2 v233, v[2:3], s[30:31] sc1
    s_mov_b64 exec, -1
    s_cmp_eq_u32 s63, 0
    s_cbranch_scc1 go_19
    v_add_u32 v1, 98304, v240
    ds_read_b64_tr_b16 v[192:193], v1 offset:0
    ds_read_b64_tr_b16 v[194:195], v1 offset:4096
    ds_read_b64_tr_b16 v[208:209], v1 offset:32
    ds_read_b64_tr_b16 v[210:211], v1 offset:4128
    ds_read_b64_tr_b16 v[196:197], v1 offset:8192
    ds_read_b64_tr_b16 v[198:199], v1 offset:12288
    ds_read_b64_tr_b16 v[212:213], v1 offset:8224
    ds_read_b64_tr_b16 v[214:215], v1 offset:12320
    ds_read_b64_tr_b16 v[200:201], v1 offset:16384
    ds_read_b64_tr_b16 v[202:203], v1 offset:20480
    ds_read_b64_tr_b16 v[216:217], v1 offset:16416
    ds_read_b64_tr_b16 v[218:219], v1 offset:20512
    ds_read_b64_tr_b16 v[204:205], v1 offset:24576
    ds_read_b64_tr_b16 v[206:207], v1 offset:28672
    ds_read_b64_tr_b16 v[220:221], v1 offset:24608
    ds_read_b64_tr_b16 v[222:223], v1 offset:28704
    s_barrier
gor_20:
L_e2:
    global_load_dwordx2 v[4:5], v234, s[30:31] offset:0 sc1
    global_load_dwordx2 v[6:7], v234, s[30:31] offset:512 sc1
    global_load_dwordx4 v[68:71], v235, s[30:31] offset:0 sc1
    global_load_dwordx4 v[72:75], v235, s[30:31] offset:1024 sc1
    global_load_dwordx4 v[76:79], v235, s[30:31] offset:2048 sc1
    global_load_dwordx4 v[80:83], v235, s[30:31] offset:3072 sc1
    s_waitcnt vmcnt(4)
    v_max_f32 v9, v4, v6
    v_mov_b32 v13, v9
    v_max3_u32 v1, v4, v5, v6
    v_max_u32 v1, v1, v7
    v_permlane16_swap_b32 v9, v13
    v_max_f32 v9, v9, v13
    v_mov_b32 v13, v9
    s_nop 1
    v_permlane32_swap_b32 v9, v13
    v_max_f32 v9, v9, v13
    v_sub_f32 v10, v4, v9
    v_sub_f32 v12, v6, v9
    v_exp_f32 v10, v10
    v_exp_f32 v12, v12
    v_cvt_pk_bf16_f32 v10, v10, v10
    v_cvt_pk_bf16_f32 v12, v12, v12
    v_and_b32 v84, v108, v10
    v_and_b32 v85, v109, v10
    v_and_b32 v86, v110, v10
    v_and_b32 v87, v111, v10
    v_and_b32 v88, v108, v12
    v_and_b32 v89, v109, v12
    v_and_b32 v90, v110, v12
    v_and_b32 v91, v111, v12
    s_waitcnt vmcnt(3)
    v_mfma_f32_16x16x32_bf16 v[64:67], v[84:87], v[68:71], 0
    v_and_b32 v10, 0xffff0000, v10
    v_and_b32 v12, 0xffff0000, v12
    s_waitcnt vmcnt(2)
    v_mfma_f32_16x16x32_bf16 v[64:67], v[88:91], v[72:75], v[64:67]
    v_mul_f32 v11, v10, v5
    v_fmac_f32 v11, v12, v7
    s_waitcnt vmcnt(1)
    v_mfma_f32_16x16x32_bf16 v[60:63], v[84:87], v[76:79], 0
    v_mov_b32 v13, v11
    s_waitcnt vmcnt(0)
    v_mfma_f32_16x16x32_bf16 v[60:63], v[88:91], v[80:83], v[60:63]
    v_permlane16_swap_b32 v11, v13
    v_add_f32 v11, v11, v13
    v_mov_b32 v13, v11
    v_max3_u32 v1, v1, v68, v69
    v_max3_u32 v1, v1, v70, v71
    v_permlane32_swap_b32 v11, v13
    v_add_f32 v11, v11, v13
    v_max3_u32 v1, v1, v72, v73
    v_max3_u32 v1, v1, v74, v75
    v_mov_b32_dpp v13, v11 row_ror:8 row_mask:0xf bank_mask:0xf
    v_max3_u32 v1, v1, v76, v77
    v_max3_u32 v1, v1, v78, v79
    v_cndmask_b32 v11, v11, v13, s[60:61]
    v_max3_u32 v1, v1, v80, v81
    v_max3_u32 v1, v1, v82, v83
    v_rcp_f32 v11, v11
    v_cmp_eq_u32 vcc, -1, v1
    v_cndmask_b32 v64, v64, v60, s[58:59]
    v_cndmask_b32 v65, v65, v61, s[58:59]
    v_cndmask_b32 v66, v66, v62, s[58:59]
    v_cndmask_b32 v67, v67, v63, s[58:59]
    v_mul_f32 v64, v11, v64
    v_mul_f32 v65, v11, v65
    v_mul_f32 v66, v11, v66
    v_mul_f32 v67, v11, v67
    v_cvt_pk_bf16_f32 v64, v64, v65
    v_cvt_pk_bf16_f32 v65, v66, v67
    s_cbranch_vccnz rt_21
    ds_write_b64 v247, v[64:65]
    s_cmp_eq_u32 s63, 0
    s_cbranch_scc1 l0_22
l0r_23:
    s_cmp_eq_u32 s63, 0
    s_cbranch_scc1 sy_24
    s_waitcnt lgkmcnt(0)
    s_barrier
syr_25:
    ds_read_b128 v[84:87], v245 offset:2048
    ds_read_b128 v[88:91], v246 offset:2560
    ds_read_b128 v[92:95], v245 offset:3072
    ds_read_b128 v[96:99], v246 offset:3584
    s_waitcnt lgkmcnt(3)
    v_mfma_f32_16x16x32_bf16 v[32:35], v[192:195], v[84:87], 0
    v_mfma_f32_16x16x32_bf16 v[36:39], v[208:211], v[84:87], 0
    s_waitcnt lgkmcnt(2)
    v_mfma_f32_16x16x32_bf16 v[32:35], v[196:199], v[88:91], v[32:35]
    v_mfma_f32_16x16x32_bf16 v[36:39], v[212:215], v[88:91], v[36:39]
    s_waitcnt lgkmcnt(1)
    v_mfma_f32_16x16x32_bf16 v[32:35], v[200:203], v[92:95], v[32:35]
    v_mfma_f32_16x16x32_bf16 v[36:39], v[216:219], v[92:95], v[36:39]
    s_waitcnt lgkmcnt(0)
    v_mfma_f32_16x16x32_bf16 v[32:35], v[204:207], v[96:99], v[32:35]
    v_mfma_f32_16x16x32_bf16 v[36:39], v[220:223], v[96:99], v[36:39]
    s_nop 7
    v_mov_b32_dpp v32, v36 row_shr:8 row_mask:0xf bank_mask:0xf
    v_mov_b32_dpp v33, v37 row_shr:8 row_mask:0xf bank_mask:0xf
    v_mov_b32_dpp v34, v38 row_shr:8 row_mask:0xf bank_mask:0xf
    v_mov_b32_dpp v35, v39 row_shr:8 row_mask:0xf bank_mask:0xf
    v_bfi_b32 v32, v15, s36, v32
    v_bfi_b32 v33, v15, s37, v33
    v_bfi_b32 v34, v15, s38, v34
    v_bfi_b32 v35, v15, s39, v35
    s_cmp_eq_u32 s64, 0
    s_cbranch_scc1 ss_26
    global_store_dwordx4 v236, v[32:35], s[28:29]
ssr_27:
    s_cmp_ge_u32 s32, 28
    s_cbranch_scc1 nof_28
    s_cmp_eq_u32 s63, 0
    s_cbranch_scc1 l0_30
l0r_31:
    ds_read_b64_tr_b16 v[192:193], v240 offset:0
    ds_read_b64_tr_b16 v[194:195], v240 offset:4096
    ds_read_b64_tr_b16 v[208:209], v240 offset:32
    ds_read_b64_tr_b16 v[210:211], v240 offset:4128
    ds_read_b64_tr_b16 v[196:197], v240 offset:8192
    ds_read_b64_tr_b16 v[198:199], v240 offset:12288
    ds_read_b64_tr_b16 v[212:213], v240 offset:8224
    ds_read_b64_tr_b16 v[214:215], v240 offset:12320
    ds_read_b64_tr_b16 v[200:201], v240 offset:16384
    ds_read_b64_tr_b16 v[202:203], v240 offset:20480
    ds_read_b64_tr_b16 v[216:217], v240 offset:16416
    ds_read_b64_tr_b16 v[218:219], v240 offset:20512
    ds_read_b64_tr_b16 v[204:205], v240 offset:24576
    ds_read_b64_tr_b16 v[206:207], v240 offset:28672
    ds_read_b64_tr_b16 v[220:221], v240 offset:24608
    ds_read_b64_tr_b16 v[222:223], v240 offset:28704
    s_cmp_eq_u32 s63, 0
    s_cbranch_scc1 sy_32
    s_barrier
syr_33:
    s_mov_b32 exec_lo, 0xff00ff
    s_mov_b32 exec_hi, 0xff00ff
xs_34:
    global_load_dwordx4 v[16:19], v237, s[30:31] offset:0 sc1
    global_load_dwordx4 v[20:23], v237, s[30:31] offset:512 sc1
    global_load_dwordx4 v[24:27], v237, s[30:31] offset:1024 sc1
    global_load_dwordx4 v[28:31], v237, s[30:31] offset:1536 sc1
    s_waitcnt vmcnt(3)
    v_max3_u32 v2, v16, v17, v18
    v_max_u32 v2, v2, v19
    s_waitcnt vmcnt(2)
    v_max3_u32 v2, v2, v20, v21
    v_max3_u32 v2, v2, v22, v23
    s_waitcnt vmcnt(1)
    v_max3_u32 v2, v2, v24, v25
    v_max3_u32 v2, v2, v26, v27
    s_waitcnt vmcnt(0)
    v_max3_u32 v2, v2, v28, v29
    v_max3_u32 v2, v2, v30, v31
    v_cmp_eq_u32 vcc, -1, v2
    s_cbranch_vccnz rt_35
    s_mov_b64 exec, -1
    s_waitcnt lgkmcnt(0)
    v_mfma_f32_16x16x32_bf16 v[32:35], v[192:195], v[16:19], 0
    v_mfma_f32_16x16x32_bf16 v[36:39], v[208:211], v[16:19], 0
    s_mov_b64 exec, 1
    ds_add_u32 v253, v225 offset:52
    s_mov_b64 exec, -1
    v_mfma_f32_16x16x32_bf16 v[32:35], v[196:199], v[20:23], v[32:35]
    v_mfma_f32_16x16x32_bf16 v[36:39], v[212:215], v[20:23], v[36:39]
    v_mfma_f32_16x16x32_bf16 v[32:35], v[200:203], v[24:27], v[32:35]
    v_mfma_f32_16x16x32_bf16 v[36:39], v[216:219], v[24:27], v[36:39]
    v_mfma_f32_16x16x32_bf16 v[32:35], v[204:207], v[28:31], v[32:35]
    v_mfma_f32_16x16x32_bf16 v[36:39], v[220:223], v[28:31], v[36:39]
    s_cmp_eq_u32 s63, 0
    s_cbranch_scc1 l0_36
l0r_37:
    s_mov_b32 exec_lo, 0xff00ff
    s_mov_b32 exec_hi, 0xff00ff
    s_nop 2
    v_cvt_pk_bf16_f32 v76, v32, v33
    v_cvt_pk_bf16_f32 v77, v34, v35
    v_cvt_pk_bf16_f32 v78, v36, v37
    v_cvt_pk_bf16_f32 v79, v38, v39
    v_min_u32 v76, -2, v76
    v_min_u32 v77, -2, v77
    v_min_u32 v78, -2, v78
    v_min_u32 v79, -2, v79
    global_store_dwordx4 v238, v[76:79], s[30:31] sc1
    s_mov_b64 exec, -1
    s_cmp_eq_u32 s63, 0
    s_cbranch_scc1 go_38
    ds_read_b64_tr_b16 v[192:193], v240 offset:32768
    ds_read_b64_tr_b16 v[194:195], v240 offset:36864
    ds_read_b64_tr_b16 v[208:209], v240 offset:32800
    ds_read_b64_tr_b16 v[210:211], v240 offset:36896
    ds_read_b64_tr_b16 v[196:197], v240 offset:40960
    ds_read_b64_tr_b16 v[198:199], v240 offset:45056
    ds_read_b64_tr_b16 v[212:213], v240 offset:40992
    ds_read_b64_tr_b16 v[214:215], v240 offset:45088
    ds_read_b64_tr_b16 v[200:201], v240 offset:49152
    ds_read_b64_tr_b16 v[202:203], v240 offset:53248
    ds_read_b64_tr_b16 v[216:217], v240 offset:49184
    ds_read_b64_tr_b16 v[218:219], v240 offset:53280
    ds_read_b64_tr_b16 v[204:205], v240 offset:57344
    ds_read_b64_tr_b16 v[206:207], v240 offset:61440
    ds_read_b64_tr_b16 v[220:221], v240 offset:57376
    ds_read_b64_tr_b16 v[222:223], v240 offset:61472
    s_barrier
gor_39:
L_e5:
    global_load_dwordx4 v[84:87], v231, s[30:31] sc1
    global_load_dwordx4 v[68:71], v239, s[30:31] offset:0 sc1
    global_load_dwordx4 v[72:75], v239, s[30:31] offset:256 sc1
    global_load_dwordx4 v[76:79], v239, s[30:31] offset:2048 sc1
    global_load_dwordx4 v[80:83], v239, s[30:31] offset:2304 sc1
L_e5p:
    v_mov_b32 v12, 0xc0135761
    s_waitcnt vmcnt(3)
    v_mfma_f32_16x16x32_bf16 v[64:67], v[100:103], v[68:71], 0
    v_add_f32_dpp v11, v86, v86 row_ror:8 row_mask:0xf bank_mask:0xf
    v_add_f32_dpp v9, v84, v84 row_ror:8 row_mask:0xf bank_mask:0xf
    s_waitcnt vmcnt(2)
    v_mfma_f32_16x16x32_bf16 v[64:67], v[104:107], v[72:75], v[64:67]
    v_mov_b32 v13, v11
    v_mov_b32 v14, v9
    s_waitcnt vmcnt(1)
    v_mfma_f32_16x16x32_bf16 v[64:67], v[100:103], v[76:79], v[64:67]
    v_permlane16_swap_b32 v11, v13
    v_permlane16_swap_b32 v9, v14
    s_waitcnt vmcnt(0)
    v_mfma_f32_16x16x32_bf16 v[64:67], v[104:107], v[80:83], v[64:67]
    v_add_f32 v11, v11, v13
    v_add_f32 v9, v9, v14
    v_mov_b32 v13, v11
    v_mov_b32 v14, v9
    v_xor_b32 v2, s74, v85
    v_permlane32_swap_b32 v11, v13
    v_permlane32_swap_b32 v9, v14
    v_add_f32 v11, v11, v13
    v_add_f32 v9, v9, v14
    v_mul_f32 v11, s72, v11
    v_mul_f32 v9, s72, v9
    v_bitop3_b32 v2, v2, v87, s74 bitop3:0xf6
    v_fma_f32 v9, -v11, v11, v9
    v_max_f32 v9, 0, v9
    v_cmp_ne_u32 vcc, 0, v2
    v_add_f32 v13, s71, v9
    v_rsq_f32 v13, v13
    v_fma_f32 v88, -v11, v120, v64
    v_fma_f32 v89, -v11, v121, v65
    v_mul_f32 v9, v9, v13
    v_cndmask_b32 v1, 0, -1, vcc
    v_fma_f32 v9, v9, v13, s71
    v_rsq_f32 v9, v9
    v_fma_f32 v90, -v11, v122, v66
    v_fma_f32 v91, -v11, v123, v67
    v_mul_f32 v9, v9, v13
    v_fma_f32 v88, v88, v9, v124
    v_fma_f32 v89, v89, v9, v125
    v_fma_f32 v90, v90, v9, v126
    v_fma_f32 v91, v91, v9, v127
    v_mul_f32 v92, v88, v88
    v_mul_f32 v93, v89, v89
    v_mul_f32 v94, v90, v90
    v_mul_f32 v95, v91, v91
    v_fma_f32 v92, v92, s73, v12
    v_fma_f32 v93, v93, s73, v12
    v_fma_f32 v94, v94, s73, v12
    v_fma_f32 v95, v95, s73, v12
    v_mul_f32 v92, v92, v88
    v_mul_f32 v93, v93, v89
    v_mul_f32 v94, v94, v90
    v_mul_f32 v95, v95, v91
    v_exp_f32 v92, v92
    v_exp_f32 v93, v93
    v_exp_f32 v94, v94
    v_exp_f32 v95, v95
    v_add_f32 v92, 1.0, v92
    v_add_f32 v93, 1.0, v93
    v_add_f32 v94, 1.0, v94
    v_add_f32 v95, 1.0, v95
    v_rcp_f32 v92, v92
    v_rcp_f32 v93, v93
    v_rcp_f32 v94, v94
    v_rcp_f32 v95, v95
    v_max3_u32 v1, v1, v68, v69
    v_max3_u32 v1, v1, v70, v71
    v_max3_u32 v1, v1, v72, v73
    v_max3_u32 v1, v1, v74, v75
    v_max3_u32 v1, v1, v76, v77
    v_max3_u32 v1, v1, v78, v79
    v_max3_u32 v1, v1, v80, v81
    v_max3_u32 v1, v1, v82, v83
    v_cmp_eq_u32 vcc, -1, v1
    v_mul_f32 v88, v88, v92
    v_mul_f32 v89, v89, v93
    v_mul_f32 v90, v90, v94
    v_mul_f32 v91, v91, v95
    v_cvt_pk_bf16_f32 v88, v88, v89
    v_cvt_pk_bf16_f32 v89, v90, v91
    s_cbranch_vccnz rt_40
    ds_write_b64 v248, v[88:89]
    s_cmp_eq_u32 s63, 0
    s_cbranch_scc1 l0_41
l0r_42:
    s_cmp_eq_u32 s63, 0
    s_cbranch_scc1 sy_43
    s_waitcnt lgkmcnt(0)
    s_barrier
syr_44:
    ds_read_b128 v[84:87], v245 offset:4096
    ds_read_b128 v[88:91], v246 offset:4608
    ds_read_b128 v[92:95], v245 offset:5120
    ds_read_b128 v[96:99], v246 offset:5632
    s_waitcnt lgkmcnt(3)
    v_mfma_f32_16x16x32_bf16 v[32:35], v[192:195], v[84:87], 0
    v_mfma_f32_16x16x32_bf16 v[36:39], v[208:211], v[84:87], 0
    s_waitcnt lgkmcnt(2)
    v_mfma_f32_16x16x32_bf16 v[32:35], v[196:199], v[88:91], v[32:35]
    v_mfma_f32_16x16x32_bf16 v[36:39], v[212:215], v[88:91], v[36:39]
    s_waitcnt lgkmcnt(1)
    v_mfma_f32_16x16x32_bf16 v[32:35], v[200:203], v[92:95], v[32:35]
    v_mfma_f32_16x16x32_bf16 v[36:39], v[216:219], v[92:95], v[36:39]
    s_waitcnt lgkmcnt(0)
    v_mfma_f32_16x16x32_bf16 v[32:35], v[204:207], v[96:99], v[32:35]
    v_mfma_f32_16x16x32_bf16 v[36:39], v[220:223], v[96:99], v[36:39]
    s_nop 7
    v_mov_b32_dpp v32, v36 row_shr:8 row_mask:0xf bank_mask:0xf
    v_mov_b32_dpp v33, v37 row_shr:8 row_mask:0xf bank_mask:0xf
    v_mov_b32_dpp v34, v38 row_shr:8 row_mask:0xf bank_mask:0xf
    v_mov_b32_dpp v35, v39 row_shr:8 row_mask:0xf bank_mask:0xf
    v_bfi_b32 v32, v15, s40, v32
    v_bfi_b32 v33, v15, s41, v33
    v_bfi_b32 v34, v15, s42, v34
    v_bfi_b32 v35, v15, s43, v35
    s_cmp_eq_u32 s64, 0
    s_cbranch_scc1 ss_45
    global_store_dwordx4 v236, v[32:35], s[28:29]
ssr_46:
fend_29:
    s_cmp_lg_u32 s63, 0
    s_cbranch_scc1 L_fin2
    v_add_u32 v9, 0x4000, v237
lw_47:
    ds_read_b32 v4, v253 offset:16
    s_waitcnt lgkmcnt(0)
    v_cmp_gt_u32 vcc, 2, v4
    s_cbranch_vccnz rt_48
    s_mov_b32 exec_lo, 0xff00ff
    s_mov_b32 exec_hi, 0xff00ff
xs_49:
    global_load_dwordx4 v[16:19], v9, s[30:31] offset:0 sc1
    global_load_dwordx4 v[20:23], v9, s[30:31] offset:512 sc1
    global_load_dwordx4 v[24:27], v9, s[30:31] offset:1024 sc1
    global_load_dwordx4 v[28:31], v9, s[30:31] offset:1536 sc1
    s_waitcnt vmcnt(3)
    v_max3_u32 v2, v16, v17, v18
    v_max_u32 v2, v2, v19
    s_waitcnt vmcnt(2)
    v_max3_u32 v2, v2, v20, v21
    v_max3_u32 v2, v2, v22, v23
    s_waitcnt vmcnt(1)
    v_max3_u32 v2, v2, v24, v25
    v_max3_u32 v2, v2, v26, v27
    s_waitcnt vmcnt(0)
    v_max3_u32 v2, v2, v28, v29
    v_max3_u32 v2, v2, v30, v31
    v_cmp_eq_u32 vcc, -1, v2
    s_cbranch_vccnz rt_50
    s_mov_b64 exec, -1
    s_mov_b32 s63, 1
    s_add_u32 s30, s30, 0x200000
    s_addc_u32 s31, s31, 0
    s_xor_b32 s36, s36, 2
    s_xor_b32 s37, s37, 2
    s_xor_b32 s38, s38, 2
    s_xor_b32 s39, s39, 2
    s_xor_b32 s40, s40, 2
    s_xor_b32 s41, s41, 2
    s_xor_b32 s42, s42, 2
    s_xor_b32 s43, s43, 2
    s_mov_b32 s67, 8
    s_branch L_layer
L_fin2:
L_dump:
L_end:
    s_endpgm
e_1:
    global_load_dwordx2 v[126:127], v13, s[18:19]
    s_nop 4
    s_branch er_2
rt_4:
    s_sleep 1
    s_add_u32 s65, s65, 1
    s_cmp_lt_u32 s65, 40000
    s_cbranch_scc1 lw_3
    s_endpgm
rt_6:
    s_sleep 2
    s_add_u32 s65, s65, 1
    s_cmp_lt_u32 s65, 40000
    s_cbranch_scc1 lw_5
    s_endpgm
l0_7:
    s_mov_b32 exec_lo, 0x0
    s_mov_b32 exec_hi, 0xffff
    global_store_dword v120, v68, s[28:29] sc1
    s_mov_b64 exec, -1
    s_nop 4
    s_branch l0r_8
l0q_9:
    s_mov_b64 exec, 1
    ds_add_u32 v253, v225 offset:20
    s_mov_b64 exec, -1
    v_lshlrev_b32 v124, 16, v126
    v_and_b32 v125, 0xffff0000, v126
    v_lshlrev_b32 v126, 16, v127
    v_and_b32 v127, 0xffff0000, v127
lw_51:
    ds_read_b32 v4, v253 offset:32
    s_waitcnt lgkmcnt(0)
    v_cmp_gt_u32 vcc, 1, v4
    s_cbranch_vccnz rt_52
    global_load_dwordx4 v[40:43], v121, s[28:29] offset:0 sc1
    global_load_dwordx4 v[44:47], v121, s[28:29] offset:1024 sc1
    global_load_dwordx4 v[48:51], v121, s[28:29] offset:2048 sc1
    global_load_dwordx4 v[52:55], v121, s[28:29] offset:3072 sc1
    global_load_dwordx4 v[68:71], v229, s[30:31] offset:0 sc1
    global_load_dwordx4 v[72:75], v229, s[30:31] offset:1024 sc1
    global_load_dwordx4 v[76:79], v229, s[30:31] offset:2048 sc1
    global_load_dwordx4 v[80:83], v229, s[30:31] offset:3072 sc1
    global_load_dwordx4 v[56:59], v230, s[30:31] sc1
    s_mov_b64 exec, 1
    ds_add_u32 v253, v225 offset:56
    s_mov_b64 exec, -1
lw_53:
    ds_read_b32 v4, v253 offset:68
    s_waitcnt lgkmcnt(0)
    v_cmp_gt_u32 vcc, 1, v4
    s_cbranch_vccnz rt_54
    ds_read_b128 v[160:163], v112 offset:0
    ds_read_b128 v[164:167], v113 offset:0
    ds_read_b128 v[168:171], v114 offset:0
    ds_read_b128 v[172:175], v115 offset:0
    ds_read_b128 v[176:179], v112 offset:4096
    ds_read_b128 v[180:183], v113 offset:4096
    ds_read_b128 v[184:187], v114 offset:4096
    ds_read_b128 v[188:191], v115 offset:4096
    s_waitcnt lgkmcnt(0)
    s_mov_b64 exec, 1
    ds_add_u32 v253, v225 offset:60
    s_mov_b64 exec, -1
    s_branch cq_57
cq_56:
    global_load_dwordx4 v[40:43], v121, s[28:29] offset:0 sc1
    global_load_dwordx4 v[44:47], v121, s[28:29] offset:1024 sc1
    global_load_dwordx4 v[48:51], v121, s[28:29] offset:2048 sc1
    global_load_dwordx4 v[52:55], v121, s[28:29] offset:3072 sc1
    global_load_dwordx4 v[68:71], v229, s[30:31] offset:0 sc1
    global_load_dwordx4 v[72:75], v229, s[30:31] offset:1024 sc1
    global_load_dwordx4 v[76:79], v229, s[30:31] offset:2048 sc1
    global_load_dwordx4 v[80:83], v229, s[30:31] offset:3072 sc1
    global_load_dwordx4 v[56:59], v230, s[30:31] sc1
cq_57:
    s_waitcnt vmcnt(5)
    v_max3_u32 v1, v40, v41, v42
    v_max3_u32 v1, v1, v43, v44
    v_max3_u32 v1, v1, v45, v46
    v_max3_u32 v1, v1, v47, v48
    v_max3_u32 v1, v1, v49, v50
    v_max3_u32 v1, v1, v51, v52
    v_max3_u32 v1, v1, v53, v54
    v_max_u32 v1, v1, v55
    v_cmp_eq_u32 vcc, -1, v1
    s_cbranch_vccnz rt_58
    v_mfma_f32_16x16x32_bf16 v[64:67], v[100:103], v[40:43], 0
    v_mfma_f32_16x16x32_bf16 v[64:67], v[100:103], v[44:47], v[64:67]
    v_mfma_f32_16x16x32_bf16 v[64:67], v[104:107], v[48:51], v[64:67]
    v_mfma_f32_16x16x32_bf16 v[64:67], v[104:107], v[52:55], v[64:67]
    s_nop 7
    v_cvt_pk_bf16_f32 v2, v64, v66
    v_cvt_pk_bf16_f32 v3, v65, v67
    ds_write_b32 v243, v2 offset:2048
    ds_write_b32 v244, v3 offset:2048
    s_mov_b64 exec, 1
    ds_add_u32 v253, v225 offset:24
    s_mov_b64 exec, -1
lw_59:
    ds_read_b32 v4, v253 offset:24
    s_waitcnt lgkmcnt(0)
    v_cmp_gt_u32 vcc, 4, v4
    s_cbranch_vccnz rt_60
    ds_read_b128 v[84:87], v245 offset:2048
    ds_read_b128 v[88:91], v246 offset:2560
    ds_read_b128 v[92:95], v245 offset:3072
    ds_read_b128 v[96:99], v246 offset:3584
    s_waitcnt lgkmcnt(0)
    v_mfma_f32_16x16x32_bf16 v[32:35], v[160:163], v[84:87], 0
    v_mfma_f32_16x16x32_bf16 v[36:39], v[176:179], v[84:87], 0
    v_mfma_f32_16x16x32_bf16 v[32:35], v[164:167], v[88:91], v[32:35]
    v_mfma_f32_16x16x32_bf16 v[36:39], v[180:183], v[88:91], v[36:39]
    v_mfma_f32_16x16x32_bf16 v[32:35], v[168:171], v[92:95], v[32:35]
    v_mfma_f32_16x16x32_bf16 v[36:39], v[184:187], v[92:95], v[36:39]
    v_mfma_f32_16x16x32_bf16 v[32:35], v[172:175], v[96:99], v[32:35]
    v_mfma_f32_16x16x32_bf16 v[36:39], v[188:191], v[96:99], v[36:39]
    s_nop 6
    v_mov_b32 v112, v32
    v_mov_b32 v113, v33
    v_mov_b32 v114, v34
    v_mov_b32 v115, v35
    v_mov_b32 v116, v36
    v_mov_b32 v117, v37
    v_mov_b32 v118, v38
    v_mov_b32 v119, v39
    s_branch L_e1p
rt_10:
    s_sleep 4
    s_add_u32 s65, s65, 1
    s_cmp_lt_u32 s65, 40000
    s_cbranch_scc1 L_e1
    s_endpgm
fsr_12:
lw_61:
    ds_read_b32 v4, v253 offset:0
    s_waitcnt lgkmcnt(0)
    v_cmp_gt_u32 vcc, s67, v4
    s_cbranch_vccnz rt_62
    s_branch fs_11
sta_13:
sta_63:
    global_load_dwordx4 v[56:59], v230, s[30:31] sc1
    s_waitcnt vmcnt(0)
    v_add_f32_dpp v11, v58, v58 row_ror:8 row_mask:0xf bank_mask:0xf
    v_add_f32_dpp v9, v56, v56 row_ror:8 row_mask:0xf bank_mask:0xf
    v_xor_b32 v2, s74, v57
    v_mov_b32 v13, v11
    v_mov_b32 v14, v9
    v_bitop3_b32 v2, v2, v59, s74 bitop3:0xf6
    v_permlane16_swap_b32 v11, v13
    v_permlane16_swap_b32 v9, v14
    v_add_f32 v11, v11, v13
    v_add_f32 v9, v9, v14
    v_mov_b32 v13, v11
    v_mov_b32 v14, v9
    v_cmp_ne_u32 s[46:47], 0, v2
    v_permlane32_swap_b32 v11, v13
    v_permlane32_swap_b32 v9, v14
    v_add_f32 v11, v11, v13
    v_add_f32 v9, v9, v14
    s_mov_b64 vcc, s[46:47]
    s_cbranch_vccnz rt_64
    v_mul_f32 v11, s72, v11
    v_mul_f32 v9, s72, v9
    v_fma_f32 v9, -v11, v11, v9
    v_max_f32 v9, 0, v9
    v_add_f32 v9, s71, v9
    v_rsq_f32 v9, v9
    s_nop 0
    v_mul_f32 v9, s70, v9
    s_nop 4
    s_branch star_14
v_15:
lw_65:
    ds_read_b32 v4, v253 offset:72
    s_waitcnt lgkmcnt(0)
    v_cmp_gt_u32 vcc, 1, v4
    s_cbranch_vccnz rt_66
    v_xor_b32 v12, 64, v241
    v_xor_b32 v13, 128, v241
    v_xor_b32 v14, 192, v241
    ds_read_b64_tr_b16 v[192:193], v241 offset:0
    ds_read_b64_tr_b16 v[194:195], v241 offset:4096
    ds_read_b64_tr_b16 v[196:197], v241 offset:32
    ds_read_b64_tr_b16 v[198:199], v241 offset:4128
    ds_read_b64_tr_b16 v[200:201], v12 offset:0
    ds_read_b64_tr_b16 v[202:203], v12 offset:4096
    ds_read_b64_tr_b16 v[204:205], v12 offset:32
    ds_read_b64_tr_b16 v[206:207], v12 offset:4128
    ds_read_b64_tr_b16 v[208:209], v13 offset:0
    ds_read_b64_tr_b16 v[210:211], v13 offset:4096
    ds_read_b64_tr_b16 v[212:213], v13 offset:32
    ds_read_b64_tr_b16 v[214:215], v13 offset:4128
    ds_read_b64_tr_b16 v[216:217], v14 offset:0
    ds_read_b64_tr_b16 v[218:219], v14 offset:4096
    ds_read_b64_tr_b16 v[220:221], v14 offset:32
    ds_read_b64_tr_b16 v[222:223], v14 offset:4128
    s_waitcnt lgkmcnt(0)
    s_nop 4
    s_branch vr_16
fsr_18:
lw_67:
    ds_read_b32 v4, v253 offset:4
    s_waitcnt lgkmcnt(0)
    v_cmp_gt_u32 vcc, s67, v4
    s_cbranch_vccnz rt_68
    s_branch fs_17
go_19:
lw_69:
    ds_read_b32 v4, v253 offset:40
    s_waitcnt lgkmcnt(0)
    v_cmp_gt_u32 vcc, 1, v4
    s_cbranch_vccnz rt_70
    s_nop 4
    s_branch gor_20
rt_21:
    s_sleep 4
    s_add_u32 s65, s65, 1
    s_cmp_lt_u32 s65, 40000
    s_cbranch_scc1 L_e2
    s_endpgm
l0_22:
lw_71:
    ds_read_b32 v4, v253 offset:76
    s_waitcnt lgkmcnt(0)
    v_cmp_gt_u32 vcc, 1, v4
    s_cbranch_vccnz rt_72
    v_add_u32 v1, 98304, v240
    ds_read_b64_tr_b16 v[192:193], v1 offset:0
    ds_read_b64_tr_b16 v[194:195], v1 offset:4096
    ds_read_b64_tr_b16 v[208:209], v1 offset:32
    ds_read_b64_tr_b16 v[210:211], v1 offset:4128
    ds_read_b64_tr_b16 v[196:197], v1 offset:8192
    ds_read_b64_tr_b16 v[198:199], v1 offset:12288
    ds_read_b64_tr_b16 v[212:213], v1 offset:8224
    ds_read_b64_tr_b16 v[214:215], v1 offset:12320
    ds_read_b64_tr_b16 v[200:201], v1 offset:16384
    ds_read_b64_tr_b16 v[202:203], v1 offset:20480
    ds_read_b64_tr_b16 v[216:217], v1 offset:16416
    ds_read_b64_tr_b16 v[218:219], v1 offset:20512
    ds_read_b64_tr_b16 v[204:205], v1 offset:24576
    ds_read_b64_tr_b16 v[206:207], v1 offset:28672
    ds_read_b64_tr_b16 v[220:221], v1 offset:24608
    ds_read_b64_tr_b16 v[222:223], v1 offset:28704
lw_73:
    ds_read_b32 v4, v253 offset:36
    s_waitcnt lgkmcnt(0)
    v_cmp_gt_u32 vcc, 1, v4
    s_cbranch_vccnz rt_74
    v_readfirstlane_b32 s64, v4
    s_nop 0
    s_sub_u32 s64, s64, 1
    s_nop 4
    s_branch l0r_23
sy_24:
    s_mov_b64 exec, 1
    ds_add_u32 v253, v225 offset:8
    s_mov_b64 exec, -1
lw_75:
    ds_read_b32 v4, v253 offset:8
    s_waitcnt lgkmcnt(0)
    v_cmp_gt_u32 vcc, 4, v4
    s_cbranch_vccnz rt_76
    s_nop 4
    s_branch syr_25
ss_26:
    global_store_dwordx4 v236, v[32:35], s[28:29] sc1
    s_nop 4
    s_branch ssr_27
l0_30:
lw_77:
    ds_read_b32 v4, v253 offset:80
    s_waitcnt lgkmcnt(0)
    v_cmp_gt_u32 vcc, 1, v4
    s_cbranch_vccnz rt_78
    s_nop 4
    s_branch l0r_31
sy_32:
lw_79:
    ds_read_b32 v4, v253 offset:16
    s_waitcnt lgkmcnt(0)
    v_cmp_gt_u32 vcc, 1, v4
    s_cbranch_vccnz rt_80
    s_nop 4
    s_branch syr_33
rt_35:
    s_add_u32 s65, s65, 1
    s_cmp_lt_u32 s65, 40000
    s_cbranch_scc1 xs_34
    s_endpgm
l0_36:
    s_nop 4
    v_bfi_b32 v68, v15, s40, v32
    v_bfi_b32 v69, v15, s41, v33
    v_bfi_b32 v70, v15, s42, v34
    v_bfi_b32 v71, v15, s43, v35
    v_bfi_b32 v72, v15, s40, v36
    v_bfi_b32 v73, v15, s41, v37
    v_bfi_b32 v74, v15, s42, v38
    v_bfi_b32 v75, v15, s43, v39
    s_mov_b32 exec_lo, 0x1000100
    s_mov_b32 exec_hi, 0x1000100
    global_store_dwordx4 v122, v[68:71], s[28:29] sc1
    global_store_dwordx4 v122, v[72:75], s[28:29] offset:64 sc1
    s_mov_b64 exec, -1
    s_nop 4
    s_branch l0r_37
go_38:
lw_81:
    ds_read_b32 v4, v253 offset:44
    s_waitcnt lgkmcnt(0)
    v_cmp_gt_u32 vcc, 1, v4
    s_cbranch_vccnz rt_82
    v_bfe_u32 v12, v0, 4, 1
    v_lshrrev_b32 v13, 5, v0
    v_bfe_u32 v14, v0, 3, 1
    s_lshl_b32 s44, s32, 12
    s_lshl_b32 s45, s35, 10
    s_add_u32 s44, s44, s45
    s_add_u32 s44, s44, 0x520000
    v_lshl_add_u32 v10, v12, 6, s44
    v_lshl_add_u32 v10, v13, 5, v10
    v_lshl_add_u32 v10, v14, 4, v10
c1_83:
    global_load_dwordx4 v[32:35], v10, s[28:29] offset:0 sc1
    global_load_dwordx4 v[36:39], v10, s[28:29] offset:128 sc1
    global_load_dwordx4 v[40:43], v10, s[28:29] offset:256 sc1
    global_load_dwordx4 v[44:47], v10, s[28:29] offset:384 sc1
    global_load_dwordx4 v[48:51], v10, s[28:29] offset:512 sc1
    global_load_dwordx4 v[52:55], v10, s[28:29] offset:640 sc1
    global_load_dwordx4 v[56:59], v10, s[28:29] offset:768 sc1
    global_load_dwordx4 v[60:63], v10, s[28:29] offset:896 sc1
    global_load_dwordx4 v[84:87], v231, s[30:31] sc1
    global_load_dwordx4 v[68:71], v239, s[30:31] offset:0 sc1
    global_load_dwordx4 v[72:75], v239, s[30:31] offset:256 sc1
    global_load_dwordx4 v[76:79], v239, s[30:31] offset:2048 sc1
    global_load_dwordx4 v[80:83], v239, s[30:31] offset:2304 sc1
    s_waitcnt vmcnt(12)
    v_xor_b32 v32, s40, v32
    v_xor_b32 v33, s41, v33
    v_xor_b32 v34, s42, v34
    v_xor_b32 v35, s43, v35
    v_or3_b32 v1, v32, v33, v34
    v_or_b32 v1, v1, v35
    s_waitcnt vmcnt(11)
    v_xor_b32 v36, s40, v36
    v_xor_b32 v37, s41, v37
    v_xor_b32 v38, s42, v38
    v_xor_b32 v39, s43, v39
    v_or3_b32 v1, v1, v36, v37
    v_or3_b32 v1, v1, v38, v39
    v_pk_add_f32 v[120:121], v[32:33], v[36:37]
    v_pk_add_f32 v[122:123], v[34:35], v[38:39]
    s_waitcnt vmcnt(10)
    v_xor_b32 v40, s40, v40
    v_xor_b32 v41, s41, v41
    v_xor_b32 v42, s42, v42
    v_xor_b32 v43, s43, v43
    v_or3_b32 v1, v1, v40, v41
    v_or3_b32 v1, v1, v42, v43
    v_pk_add_f32 v[120:121], v[120:121], v[40:41]
    v_pk_add_f32 v[122:123], v[122:123], v[42:43]
    s_waitcnt vmcnt(9)
    v_xor_b32 v44, s40, v44
    v_xor_b32 v45, s41, v45
    v_xor_b32 v46, s42, v46
    v_xor_b32 v47, s43, v47
    v_or3_b32 v1, v1, v44, v45
    v_or3_b32 v1, v1, v46, v47
    v_pk_add_f32 v[120:121], v[120:121], v[44:45]
    v_pk_add_f32 v[122:123], v[122:123], v[46:47]
    s_waitcnt vmcnt(8)
    v_xor_b32 v48, s40, v48
    v_xor_b32 v49, s41, v49
    v_xor_b32 v50, s42, v50
    v_xor_b32 v51, s43, v51
    v_or3_b32 v1, v1, v48, v49
    v_or3_b32 v1, v1, v50, v51
    v_pk_add_f32 v[120:121], v[120:121], v[48:49]
    v_pk_add_f32 v[122:123], v[122:123], v[50:51]
    s_waitcnt vmcnt(7)
    v_xor_b32 v52, s40, v52
    v_xor_b32 v53, s41, v53
    v_xor_b32 v54, s42, v54
    v_xor_b32 v55, s43, v55
    v_or3_b32 v1, v1, v52, v53
    v_or3_b32 v1, v1, v54, v55
    v_pk_add_f32 v[120:121], v[120:121], v[52:53]
    v_pk_add_f32 v[122:123], v[122:123], v[54:55]
    s_waitcnt vmcnt(6)
    v_xor_b32 v56, s40, v56
    v_xor_b32 v57, s41, v57
    v_xor_b32 v58, s42, v58
    v_xor_b32 v59, s43, v59
    v_or3_b32 v1, v1, v56, v57
    v_or3_b32 v1, v1, v58, v59
    v_pk_add_f32 v[120:121], v[120:121], v[56:57]
    v_pk_add_f32 v[122:123], v[122:123], v[58:59]
    s_waitcnt vmcnt(5)
    v_xor_b32 v60, s40, v60
    v_xor_b32 v61, s41, v61
    v_xor_b32 v62, s42, v62
    v_xor_b32 v63, s43, v63
    v_or3_b32 v1, v1, v60, v61
    v_or3_b32 v1, v1, v62, v63
    v_pk_add_f32 v[120:121], v[120:121], v[60:61]
    v_pk_add_f32 v[122:123], v[122:123], v[62:63]
    v_and_b32 v1, 0xff, v1
    v_cmp_ne_u32 vcc, 0, v1
    s_cbranch_vccnz rt_84
    s_branch L_e5p
rt_40:
    s_sleep 4
    s_add_u32 s65, s65, 1
    s_cmp_lt_u32 s65, 40000
    s_cbranch_scc1 L_e5
    s_endpgm
l0_41:
lw_85:
    ds_read_b32 v4, v253 offset:84
    s_waitcnt lgkmcnt(0)
    v_cmp_gt_u32 vcc, 1, v4
    s_cbranch_vccnz rt_86
    ds_read_b64_tr_b16 v[192:193], v240 offset:32768
    ds_read_b64_tr_b16 v[194:195], v240 offset:36864
    ds_read_b64_tr_b16 v[208:209], v240 offset:32800
    ds_read_b64_tr_b16 v[210:211], v240 offset:36896
    ds_read_b64_tr_b16 v[196:197], v240 offset:40960
    ds_read_b64_tr_b16 v[198:199], v240 offset:45056
    ds_read_b64_tr_b16 v[212:213], v240 offset:40992
    ds_read_b64_tr_b16 v[214:215], v240 offset:45088
    ds_read_b64_tr_b16 v[200:201], v240 offset:49152
    ds_read_b64_tr_b16 v[202:203], v240 offset:53248
    ds_read_b64_tr_b16 v[216:217], v240 offset:49184
    ds_read_b64_tr_b16 v[218:219], v240 offset:53280
    ds_read_b64_tr_b16 v[204:205], v240 offset:57344
    ds_read_b64_tr_b16 v[206:207], v240 offset:61440
    ds_read_b64_tr_b16 v[220:221], v240 offset:57376
    ds_read_b64_tr_b16 v[222:223], v240 offset:61472
    s_nop 4
    s_branch l0r_42
sy_43:
    s_mov_b64 exec, 1
    ds_add_u32 v253, v225 offset:12
    s_mov_b64 exec, -1
lw_87:
    ds_read_b32 v4, v253 offset:12
    s_waitcnt lgkmcnt(0)
    v_cmp_gt_u32 vcc, 4, v4
    s_cbranch_vccnz rt_88
    s_nop 4
    s_branch syr_44
ss_45:
    global_store_dwordx4 v236, v[32:35], s[28:29] sc1
    s_nop 4
    s_branch ssr_46
nof_28:
    s_cmp_eq_u32 s63, 0
    s_cbranch_scc1 sy_89
    s_barrier
syr_90:
    s_cmp_eq_u32 s63, 0
    s_cbranch_scc1 sy_91
    s_barrier
syr_92:
    s_cmp_eq_u32 s63, 0
    s_cbranch_scc1 sy_93
    s_waitcnt lgkmcnt(0)
    s_barrier
syr_94:
    s_nop 4
    s_branch fend_29
rt_48:
    s_add_u32 s65, s65, 1
    s_cmp_lt_u32 s65, 40000
    s_cbranch_scc1 lw_47
    s_endpgm
rt_50:
    s_add_u32 s65, s65, 1
    s_cmp_lt_u32 s65, 40000
    s_cbranch_scc1 xs_49
    s_endpgm
rt_52:
    s_sleep 1
    s_add_u32 s65, s65, 1
    s_cmp_lt_u32 s65, 40000
    s_cbranch_scc1 lw_51
    s_endpgm
rt_54:
    s_sleep 2
    s_add_u32 s65, s65, 1
    s_cmp_lt_u32 s65, 40000
    s_cbranch_scc1 lw_53
    s_endpgm
rt_58:
    s_sleep 4
    s_add_u32 s65, s65, 1
    s_cmp_lt_u32 s65, 40000
    s_cbranch_scc1 cq_56
    s_endpgm
rt_60:
    s_add_u32 s65, s65, 1
    s_cmp_lt_u32 s65, 40000
    s_cbranch_scc1 lw_59
    s_endpgm
rt_62:
    s_add_u32 s65, s65, 1
    s_cmp_lt_u32 s65, 40000
    s_cbranch_scc1 lw_61
    s_endpgm
rt_64:
    s_sleep 4
    s_add_u32 s65, s65, 1
    s_cmp_lt_u32 s65, 40000
    s_cbranch_scc1 sta_63
    s_endpgm
rt_66:
    s_sleep 2
    s_add_u32 s65, s65, 1
    s_cmp_lt_u32 s65, 40000
    s_cbranch_scc1 lw_65
    s_endpgm
rt_68:
    s_add_u32 s65, s65, 1
    s_cmp_lt_u32 s65, 40000
    s_cbranch_scc1 lw_67
    s_endpgm
rt_70:
    s_sleep 1
    s_add_u32 s65, s65, 1
    s_cmp_lt_u32 s65, 40000
    s_cbranch_scc1 lw_69
    s_endpgm
rt_72:
    s_sleep 2
    s_add_u32 s65, s65, 1
    s_cmp_lt_u32 s65, 40000
    s_cbranch_scc1 lw_71
    s_endpgm
rt_74:
    s_add_u32 s65, s65, 1
    s_cmp_lt_u32 s65, 40000
    s_cbranch_scc1 lw_73
    s_endpgm
rt_76:
    s_add_u32 s65, s65, 1
    s_cmp_lt_u32 s65, 40000
    s_cbranch_scc1 lw_75
    s_endpgm
rt_78:
    s_sleep 2
    s_add_u32 s65, s65, 1
    s_cmp_lt_u32 s65, 40000
    s_cbranch_scc1 lw_77
    s_endpgm
rt_80:
    s_add_u32 s65, s65, 1
    s_cmp_lt_u32 s65, 40000
    s_cbranch_scc1 lw_79
    s_endpgm
rt_82:
    s_sleep 1
    s_add_u32 s65, s65, 1
    s_cmp_lt_u32 s65, 40000
    s_cbranch_scc1 lw_81
    s_endpgm
rt_84:
    s_sleep 4
    s_add_u32 s65, s65, 1
    s_cmp_lt_u32 s65, 40000
    s_cbranch_scc1 c1_83
    s_endpgm
rt_86:
    s_sleep 2
    s_add_u32 s65, s65, 1
    s_cmp_lt_u32 s65, 40000
    s_cbranch_scc1 lw_85
    s_endpgm
rt_88:
    s_add_u32 s65, s65, 1
    s_cmp_lt_u32 s65, 40000
    s_cbranch_scc1 lw_87
    s_endpgm
sy_89:
lw_95:
    ds_read_b32 v4, v253 offset:16
    s_waitcnt lgkmcnt(0)
    v_cmp_gt_u32 vcc, 1, v4
    s_cbranch_vccnz rt_96
    s_nop 4
    s_branch syr_90
sy_91:
    s_nop 4
    s_branch syr_92
sy_93:
    s_mov_b64 exec, 1
    ds_add_u32 v253, v225 offset:12
    s_mov_b64 exec, -1
    s_nop 4
    s_branch syr_94
rt_96:
    s_add_u32 s65, s65, 1
    s_cmp_lt_u32 s65, 40000
    s_cbranch_scc1 lw_95
    s_endpgm
L_reducer:
    s_setprio 2
    v_lshlrev_b32 v1, 2, v0
    v_add_u32 v1, 154368, v1
    v_mov_b32 v2, 0
    ds_write_b32 v1, v2
    v_and_b32 v1, 15, v0
    v_lshrrev_b32 v2, 4, v0
    v_and_b32 v3, 7, v0
    v_bfe_u32 v5, v0, 3, 1
    v_lshrrev_b32 v6, 5, v0
    v_and_b32 v7, 31, v0
    v_bfe_u32 v8, v0, 2, 2
    v_and_b32 v12, 3, v0
    v_mov_b32 v168, -1
    v_mov_b32 v169, -1
    v_mov_b32 v170, -1
    v_mov_b32 v171, -1
    s_lshl_b32 s44, s33, 14
    s_lshl_b32 s45, s34, 11
    s_add_u32 s44, s44, s45
    s_lshl_b32 s45, s3, 8
    s_add_u32 s44, s44, s45
    v_lshl_add_u32 v160, v2, 16, s44
    v_lshl_add_u32 v160, v1, 4, v160
    v_add_u32 v161, 0x40000, v160
    s_lshl_b32 s44, s33, 17
    s_lshl_b32 s45, s3, 11
    s_add_u32 s44, s44, s45
    s_lshl_b32 s45, s34, 8
    s_add_u32 s44, s44, s45
    s_add_u32 s44, s44, 0x80000
    v_lshl_add_u32 v162, v2, 14, s44
    v_lshl_add_u32 v162, v1, 4, v162
    v_add_u32 v163, 0x10000, v162
    s_lshl_b32 s44, s33, 13
    s_lshl_b32 s45, s3, 10
    s_add_u32 s44, s44, s45
    s_lshl_b32 s45, s34, 7
    s_add_u32 s44, s44, s45
    s_add_u32 s44, s44, 0x180000
    v_lshl_add_u32 v166, v0, 4, s44
    s_lshl_b32 s44, s33, 14
    s_lshl_b32 s45, s34, 11
    s_add_u32 s44, s44, s45
    s_lshl_b32 s45, s3, 8
    s_add_u32 s44, s44, s45
    s_add_u32 s44, s44, 0x500000
    v_lshl_add_u32 v167, v0, 4, s44
    s_waitcnt lgkmcnt(0)
    s_add_u32 s46, s28, 0x541000
    s_addc_u32 s47, s29, 0
    s_load_dword s62, s[46:47], 0
    s_mov_b32 s30, s28
    s_mov_b32 s31, s29
    global_store_dwordx4 v160, v[168:171], s[28:29] sc1
    global_store_dwordx4 v161, v[168:171], s[28:29] sc1
    global_store_dwordx4 v162, v[168:171], s[28:29] sc1
    global_store_dwordx4 v163, v[168:171], s[28:29] sc1
    s_mov_b64 exec, 15
    global_store_dwordx4 v166, v[168:171], s[28:29] sc1
    s_mov_b32 exec_lo, 0xffff
    s_mov_b32 exec_hi, 0x0
    global_store_dwordx4 v167, v[168:171], s[28:29] sc1
    s_mov_b64 exec, -1
    s_barrier
    s_lshl_b32 s44, s32, 14
    s_lshl_b32 s45, s3, 9
    s_add_u32 s44, s44, s45
    s_add_u32 s44, s44, 0x100000
    v_lshl_add_u32 v164, v6, 12, s44
    v_lshl_add_u32 v164, v7, 4, v164
    v_add_u32 v165, 0x2000, v164
    s_lshl_b32 s44, s3, 17
    s_lshl_b32 s45, s32, 12
    s_add_u32 s44, s44, s45
    s_add_u32 s44, s44, 0x400000
    v_lshl_add_u32 v132, v0, 4, s44
    s_and_b32 s46, s32, 3
    s_bfe_u32 s47, s32, 0x10002
    s_lshl_b32 s44, s3, 11
    s_lshl_b32 s45, s33, 9
    s_add_u32 s44, s44, s45
    s_lshl_b32 s45, s46, 7
    s_add_u32 s44, s44, s45
    s_lshl_b32 s45, s47, 3
    s_add_u32 s44, s44, s45
    s_add_u32 s44, s44, 0x18c000
    v_lshl_add_u32 v133, v3, 4, s44
    v_lshl_add_u32 v133, v6, 2, v133
    v_add_u32 v134, 0x4000, v133
    s_lshl_b32 s44, s3, 8
    s_lshl_b32 s45, s32, 3
    s_add_u32 s44, s44, s45
    v_lshl_add_u32 v9, v6, 2, s44
    v_lshl_add_u32 v135, v3, 11, v9
    s_lshl_b32 s44, s33, 13
    s_add_u32 s44, s44, 0x194000
    v_lshl_add_u32 v180, v0, 7, s44
    s_lshl_b32 s44, s33, 13
    s_add_u32 s44, s44, 0x194000
    v_lshl_add_u32 v136, v0, 7, s44
    s_mov_b32 s44, 0x19c000
    v_lshl_add_u32 v137, v3, 7, s44
    s_lshl_b32 s44, s3, 7
    s_add_u32 s44, s44, 0x19c000
    v_mov_b32 v138, s44
    s_lshl_b32 s44, s3, 7
    s_add_u32 s44, s44, 0x188000
    v_lshl_add_u32 v139, v3, 4, s44
    s_lshl_b32 s44, s3, 11
    s_add_u32 s44, s44, 0x18c000
    v_lshl_add_u32 v140, v0, 4, s44
    v_add_u32 v141, 0x4000, v140
    s_lshl_b32 s44, s33, 10
    s_lshl_b32 s45, s3, 7
    s_add_u32 s44, s44, s45
    s_lshl_b32 s45, s34, 4
    s_add_u32 s44, s44, s45
    s_add_u32 s44, s44, 0x540000
    v_mov_b32 v173, s44
    s_lshl_b32 s44, s33, 10
    s_add_u32 s44, s44, 0x540000
    v_lshl_add_u32 v174, v0, 4, s44
    v_bfe_u32 v10, v0, 3, 2
    s_lshl_b32 s44, s3, 7
    s_add_u32 s44, s44, 0x540000
    v_lshl_add_u32 v175, v10, 10, s44
    v_lshl_add_u32 v175, v3, 4, v175
    v_lshrrev_b32 v10, 3, v0
    s_lshl_b32 s44, s3, 8
    v_lshl_add_u32 v11, v3, 11, s44
    v_lshl_add_u32 v11, v10, 5, v11
    s_add_u32 s72, s28, 0x200000
    s_addc_u32 s73, s29, 0
    s_getreg_b32 s70, hwreg(HW_REG_XCC_ID)
    s_and_b32 s70, s70, 15
    s_cmp_eq_u32 s32, 29
    s_cselect_b32 s68, 1, 0
    s_mov_b32 s69, 0
    s_waitcnt lgkmcnt(0)
    s_add_u32 s44, s62, 1
    s_lshl_b32 s44, s44, 3
    s_and_b32 s44, s44, 0xff
    s_xor_b32 s36, s44, 0x0
    s_xor_b32 s37, s44, 0x55
    s_xor_b32 s38, s44, 0xa3
    s_xor_b32 s39, s44, 0xce
    s_xor_b32 s40, s36, 1
    s_xor_b32 s41, s37, 1
    s_xor_b32 s42, s38, 1
    s_xor_b32 s43, s39, 1
    s_xor_b32 s74, s62, 0x2545f491
    s_mul_i32 s74, s74, 0x9e3779b1
    s_add_u32 s74, s74, 0x632be5ab
    s_xor_b32 s71, s62, 0x5bd1e995
    s_add_u32 s71, s71, 0x9e3779b9
    v_mov_b32 v176, s71
    v_mov_b32 v177, s70
    v_not_b32 v178, v176
    v_mov_b32 v179, s70
    v_mov_b32 v172, s74
    s_waitcnt vmcnt(0)
    ds_write_b32 v253, v225 offset:28
    s_mov_b64 exec, 1
    global_store_dwordx4 v173, v[176:179], s[28:29] sc1
    s_mov_b64 exec, -1
    s_cmp_eq_u32 s32, 28
    s_cbranch_scc1 pv_97
pvr_98:
    s_cmp_lt_u32 s32, 28
    s_cbranch_scc1 e_99
er_100:
    global_load_dword v68, v180, s[28:29] sc1
    global_load_dword v129, v135, s[4:5]
    global_load_dword v131, v9, s[22:23]
lw_101:
    ds_read_b32 v4, v253 offset:48
    s_waitcnt lgkmcnt(0)
    v_cmp_gt_u32 vcc, 1, v4
    s_cbranch_vccnz rt_102
    s_sleep 8
    s_sleep 8
    s_sleep 8
    s_sleep 8
    s_sleep 8
    s_sleep 8
xw_103:
    global_load_dwordx4 v[68:71], v174, s[28:29] sc1
    s_waitcnt vmcnt(0)
    v_not_b32 v70, v70
    v_xor_b32 v68, s71, v68
    v_xor_b32 v70, s71, v70
    v_xor_b32 v71, v71, v69
    v_or3_b32 v68, v68, v70, v71
    v_cmp_ne_u32 vcc, 0, v68
    s_cbranch_vccnz rt_104
    s_sleep 2
    ds_write_b32 v253, v225 offset:32
    v_lshlrev_b32 v128, 16, v129
    v_and_b32 v129, 0xffff0000, v129
    v_lshlrev_b32 v130, 16, v131
    v_and_b32 v131, 0xffff0000, v131
lw_105:
    ds_read_b32 v4, v253 offset:56
    s_waitcnt lgkmcnt(0)
    v_cmp_gt_u32 vcc, 4, v4
    s_cbranch_vccnz rt_106
    global_store_dwordx4 v160, v[168:171], s[72:73] sc1
    global_store_dwordx4 v161, v[168:171], s[72:73] sc1
    global_store_dwordx4 v162, v[168:171], s[72:73] sc1
    global_store_dwordx4 v163, v[168:171], s[72:73] sc1
    s_mov_b64 exec, 15
    global_store_dwordx4 v166, v[168:171], s[72:73] sc1
    s_mov_b64 exec, -1
    s_cmp_lt_u32 s32, 28
    s_cbranch_scc1 e_107
er_108:
xw_109:
    global_load_dwordx4 v[68:71], v175, s[28:29] sc1
    s_waitcnt vmcnt(0)
    v_not_b32 v70, v70
    v_xor_b32 v68, s71, v68
    v_xor_b32 v70, s71, v70
    v_xor_b32 v71, v71, v69
    v_or3_b32 v68, v68, v70, v71
    v_cmp_ne_u32 vcc, 0, v68
    s_cbranch_vccnz rt_110
    v_cmp_ne_u32 vcc, s70, v69
    s_nop 0
    s_cmp_eq_u64 vcc, 0
    s_cselect_b32 s64, 1, 0
    v_add_u32 v3, 0x200000, v133
    s_mov_b32 exec_lo, 0xff
    s_mov_b32 exec_hi, 0xff
    s_cmp_eq_u32 s64, 0
    s_cbranch_scc1 ss_111
    global_store_dword v133, v168, s[28:29]
ssr_112:
    s_cmp_eq_u32 s64, 0
    s_cbranch_scc1 ss_113
    global_store_dword v134, v168, s[28:29]
ssr_114:
    s_cmp_eq_u32 s64, 0
    s_cbranch_scc1 ss_115
    global_store_dword v3, v168, s[28:29]
ssr_116:
    s_mov_b64 exec, -1
    global_load_dword v69, v136, s[72:73] sc1
    s_mov_b32 exec_lo, 0xff
    s_mov_b32 exec_hi, 0x0
    global_load_dword v70, v137, s[28:29] offset:1024 sc1
    global_load_dword v71, v137, s[72:73] sc1
    global_load_dword v72, v137, s[72:73] offset:1024 sc1
    s_mov_b64 exec, -1
    s_add_u32 s44, s64, 1
    v_mov_b32 v5, s44
    s_waitcnt vmcnt(0)
    ds_write_b32 v253, v5 offset:36
lw_117:
    ds_read_b32 v4, v253 offset:4
    s_waitcnt lgkmcnt(0)
    v_cmp_gt_u32 vcc, 4, v4
    s_cbranch_vccnz rt_118
    s_sleep 8
    s_sleep 8
    s_sleep 8
    s_sleep 8
can_119:
    global_load_dword v68, v180, s[30:31] offset:0 sc1
    s_waitcnt vmcnt(0)
    v_cmp_ne_u32 vcc, s74, v68
    s_cbranch_vccnz rt_120
    s_sleep 3
    ds_write_b32 v253, v225 offset:40
    s_sleep 2
    global_load_dwordx4 v[68:71], v132, s[28:29] offset:0 sc1
    global_load_dwordx4 v[72:75], v132, s[28:29] offset:1024 sc1
    global_load_dwordx4 v[76:79], v132, s[28:29] offset:2048 sc1
    global_load_dwordx4 v[80:83], v132, s[28:29] offset:3072 sc1
    global_load_dwordx4 v[84:87], v140, s[30:31] sc1
    global_load_dwordx4 v[88:91], v140, s[30:31] offset:1024 sc1
lw_121:
    ds_read_b32 v4, v253 offset:8
    s_waitcnt lgkmcnt(0)
    v_cmp_gt_u32 vcc, 4, v4
    s_cbranch_vccnz rt_122
    global_load_dwordx4 v[68:71], v132, s[28:29] offset:0 sc1
    global_load_dwordx4 v[72:75], v132, s[28:29] offset:1024 sc1
    global_load_dwordx4 v[76:79], v132, s[28:29] offset:2048 sc1
    global_load_dwordx4 v[80:83], v132, s[28:29] offset:3072 sc1
red_123:
    global_load_dwordx4 v[84:87], v132, s[28:29] offset:0 sc1
    global_load_dwordx4 v[88:91], v132, s[28:29] offset:1024 sc1
    global_load_dwordx4 v[92:95], v132, s[28:29] offset:2048 sc1
    global_load_dwordx4 v[96:99], v132, s[28:29] offset:3072 sc1
    s_waitcnt vmcnt(7)
    v_xor_b32 v68, s36, v68
    v_xor_b32 v69, s37, v69
    v_xor_b32 v70, s38, v70
    v_xor_b32 v71, s39, v71
    v_or3_b32 v1, v68, v69, v70
    v_or_b32 v1, v1, v71
    s_waitcnt vmcnt(6)
    v_xor_b32 v72, s36, v72
    v_xor_b32 v73, s37, v73
    v_xor_b32 v74, s38, v74
    v_xor_b32 v75, s39, v75
    v_or3_b32 v1, v1, v72, v73
    v_or3_b32 v1, v1, v74, v75
    v_pk_add_f32 v[32:33], v[68:69], v[72:73]
    v_pk_add_f32 v[34:35], v[70:71], v[74:75]
    s_waitcnt vmcnt(5)
    v_xor_b32 v76, s36, v76
    v_xor_b32 v77, s37, v77
    v_xor_b32 v78, s38, v78
    v_xor_b32 v79, s39, v79
    v_or3_b32 v1, v1, v76, v77
    v_or3_b32 v1, v1, v78, v79
    v_pk_add_f32 v[32:33], v[32:33], v[76:77]
    v_pk_add_f32 v[34:35], v[34:35], v[78:79]
    s_waitcnt vmcnt(4)
    v_xor_b32 v80, s36, v80
    v_xor_b32 v81, s37, v81
    v_xor_b32 v82, s38, v82
    v_xor_b32 v83, s39, v83
    v_or3_b32 v1, v1, v80, v81
    v_or3_b32 v1, v1, v82, v83
    v_and_b32 v1, 0xff, v1
    v_cmp_ne_u32 vcc, 0, v1
    v_pk_add_f32 v[32:33], v[32:33], v[80:81]
    v_pk_add_f32 v[34:35], v[34:35], v[82:83]
    s_nop 1
    v_permlane32_swap_b32 v32, v34
    v_permlane32_swap_b32 v33, v35
    v_pk_add_f32 v[32:33], v[32:33], v[34:35]
    s_cbranch_vccz redd_124
    global_load_dwordx4 v[68:71], v132, s[28:29] offset:0 sc1
    global_load_dwordx4 v[72:75], v132, s[28:29] offset:1024 sc1
    global_load_dwordx4 v[76:79], v132, s[28:29] offset:2048 sc1
    global_load_dwordx4 v[80:83], v132, s[28:29] offset:3072 sc1
    s_waitcnt vmcnt(7)
    v_xor_b32 v84, s36, v84
    v_xor_b32 v85, s37, v85
    v_xor_b32 v86, s38, v86
    v_xor_b32 v87, s39, v87
    v_or3_b32 v1, v84, v85, v86
    v_or_b32 v1, v1, v87
    s_waitcnt vmcnt(6)
    v_xor_b32 v88, s36, v88
    v_xor_b32 v89, s37, v89
    v_xor_b32 v90, s38, v90
    v_xor_b32 v91, s39, v91
    v_or3_b32 v1, v1, v88, v89
    v_or3_b32 v1, v1, v90, v91
    v_pk_add_f32 v[32:33], v[84:85], v[88:89]
    v_pk_add_f32 v[34:35], v[86:87], v[90:91]
    s_waitcnt vmcnt(5)
    v_xor_b32 v92, s36, v92
    v_xor_b32 v93, s37, v93
    v_xor_b32 v94, s38, v94
    v_xor_b32 v95, s39, v95
    v_or3_b32 v1, v1, v92, v93
    v_or3_b32 v1, v1, v94, v95
    v_pk_add_f32 v[32:33], v[32:33], v[92:93]
    v_pk_add_f32 v[34:35], v[34:35], v[94:95]
    s_waitcnt vmcnt(4)
    v_xor_b32 v96, s36, v96
    v_xor_b32 v97, s37, v97
    v_xor_b32 v98, s38, v98
    v_xor_b32 v99, s39, v99
    v_or3_b32 v1, v1, v96, v97
    v_or3_b32 v1, v1, v98, v99
    v_and_b32 v1, 0xff, v1
    v_cmp_ne_u32 vcc, 0, v1
    v_pk_add_f32 v[32:33], v[32:33], v[96:97]
    v_pk_add_f32 v[34:35], v[34:35], v[98:99]
    s_nop 1
    v_permlane32_swap_b32 v32, v34
    v_permlane32_swap_b32 v33, v35
    v_pk_add_f32 v[32:33], v[32:33], v[34:35]
    s_cbranch_vccnz rt_125
redd_124:
    s_mov_b64 exec, s[68:69]
    global_store_dword v138, v172, s[30:31] offset:1024 sc1
    s_mov_b64 exec, -1
    v_mov_b32 v34, v32
    v_mov_b32 v35, v33
    s_nop 0
    v_permlane16_swap_b32 v32, v34
    v_permlane16_swap_b32 v33, v35
    v_add_f32 v32, v32, v34
    v_add_f32 v33, v33, v35
    s_nop 0
    v_add_f32_dpp v32, v32, v32 row_ror:8 row_mask:0xf bank_mask:0xf
    v_add_f32_dpp v33, v33, v33 row_ror:8 row_mask:0xf bank_mask:0xf
    v_pk_add_f32 v[32:33], v[32:33], v[128:129]
    s_mov_b32 exec_lo, 0xff
    s_mov_b32 exec_hi, 0xff
    v_cvt_pk_bf16_f32 v32, v32, v33
    v_min_u32 v32, -2, v32
    s_cmp_eq_u32 s64, 0
    s_cbranch_scc1 ss_126
    global_store_dword v133, v32, s[30:31]
ssr_127:
    v_lshlrev_b32 v128, 16, v32
    v_and_b32 v129, 0xffff0000, v32
    s_mov_b64 exec, -1
    s_mov_b64 exec, 1
    ds_add_u32 v253, v225 offset:16
    s_mov_b64 exec, -1
    s_cmp_eq_u32 s32, 28
    s_cbranch_scc1 pv_128
pvr_129:
    v_pk_add_f32 v[128:129], v[128:129], v[130:131]
    s_cmp_lt_u32 s32, 28
    s_cbranch_scc1 w5_130
w5r_131:
    ds_write_b32 v253, v225 offset:44
    s_sleep 2
    global_load_dwordx4 v[84:87], v141, s[30:31] sc1
    global_load_dwordx4 v[88:91], v141, s[30:31] offset:1024 sc1
lw_132:
    ds_read_b32 v4, v253 offset:12
    s_waitcnt lgkmcnt(0)
    v_cmp_gt_u32 vcc, 4, v4
    s_cbranch_vccnz rt_133
    global_load_dwordx4 v[68:71], v132, s[28:29] offset:0 sc1
    global_load_dwordx4 v[72:75], v132, s[28:29] offset:1024 sc1
    global_load_dwordx4 v[76:79], v132, s[28:29] offset:2048 sc1
    v_mov_b32 v80, s40
    v_mov_b32 v81, s41
    v_mov_b32 v82, s42
    v_mov_b32 v83, s43
    s_mov_b32 exec_lo, 0xffffffff
    s_mov_b32 exec_hi, 0x0
    global_load_dwordx4 v[80:83], v132, s[28:29] offset:3072 sc1
    s_mov_b64 exec, -1
red_134:
    global_load_dwordx4 v[84:87], v132, s[28:29] offset:0 sc1
    global_load_dwordx4 v[88:91], v132, s[28:29] offset:1024 sc1
    global_load_dwordx4 v[92:95], v132, s[28:29] offset:2048 sc1
    v_mov_b32 v96, s40
    v_mov_b32 v97, s41
    v_mov_b32 v98, s42
    v_mov_b32 v99, s43
    s_mov_b32 exec_lo, 0xffffffff
    s_mov_b32 exec_hi, 0x0
    global_load_dwordx4 v[96:99], v132, s[28:29] offset:3072 sc1
    s_mov_b64 exec, -1
    s_waitcnt vmcnt(7)
    v_xor_b32 v68, s40, v68
    v_xor_b32 v69, s41, v69
    v_xor_b32 v70, s42, v70
    v_xor_b32 v71, s43, v71
    v_or3_b32 v1, v68, v69, v70
    v_or_b32 v1, v1, v71
    s_waitcnt vmcnt(6)
    v_xor_b32 v72, s40, v72
    v_xor_b32 v73, s41, v73
    v_xor_b32 v74, s42, v74
    v_xor_b32 v75, s43, v75
    v_or3_b32 v1, v1, v72, v73
    v_or3_b32 v1, v1, v74, v75
    v_pk_add_f32 v[32:33], v[68:69], v[72:73]
    v_pk_add_f32 v[34:35], v[70:71], v[74:75]
    s_waitcnt vmcnt(5)
    v_xor_b32 v76, s40, v76
    v_xor_b32 v77, s41, v77
    v_xor_b32 v78, s42, v78
    v_xor_b32 v79, s43, v79
    v_or3_b32 v1, v1, v76, v77
    v_or3_b32 v1, v1, v78, v79
    v_pk_add_f32 v[32:33], v[32:33], v[76:77]
    v_pk_add_f32 v[34:35], v[34:35], v[78:79]
    s_waitcnt vmcnt(4)
    v_xor_b32 v80, s40, v80
    v_xor_b32 v81, s41, v81
    v_xor_b32 v82, s42, v82
    v_xor_b32 v83, s43, v83
    v_or3_b32 v1, v1, v80, v81
    v_or3_b32 v1, v1, v82, v83
    v_and_b32 v1, 0xff, v1
    v_cmp_ne_u32 vcc, 0, v1
    v_pk_add_f32 v[32:33], v[32:33], v[80:81]
    v_pk_add_f32 v[34:35], v[34:35], v[82:83]
    s_nop 1
    v_permlane32_swap_b32 v32, v34
    v_permlane32_swap_b32 v33, v35
    v_pk_add_f32 v[32:33], v[32:33], v[34:35]
    s_cbranch_vccz redd_135
    global_load_dwordx4 v[68:71], v132, s[28:29] offset:0 sc1
    global_load_dwordx4 v[72:75], v132, s[28:29] offset:1024 sc1
    global_load_dwordx4 v[76:79], v132, s[28:29] offset:2048 sc1
    v_mov_b32 v80, s40
    v_mov_b32 v81, s41
    v_mov_b32 v82, s42
    v_mov_b32 v83, s43
    s_mov_b32 exec_lo, 0xffffffff
    s_mov_b32 exec_hi, 0x0
    global_load_dwordx4 v[80:83], v132, s[28:29] offset:3072 sc1
    s_mov_b64 exec, -1
    s_waitcnt vmcnt(7)
    v_xor_b32 v84, s40, v84
    v_xor_b32 v85, s41, v85
    v_xor_b32 v86, s42, v86
    v_xor_b32 v87, s43, v87
    v_or3_b32 v1, v84, v85, v86
    v_or_b32 v1, v1, v87
    s_waitcnt vmcnt(6)
    v_xor_b32 v88, s40, v88
    v_xor_b32 v89, s41, v89
    v_xor_b32 v90, s42, v90
    v_xor_b32 v91, s43, v91
    v_or3_b32 v1, v1, v88, v89
    v_or3_b32 v1, v1, v90, v91
    v_pk_add_f32 v[32:33], v[84:85], v[88:89]
    v_pk_add_f32 v[34:35], v[86:87], v[90:91]
    s_waitcnt vmcnt(5)
    v_xor_b32 v92, s40, v92
    v_xor_b32 v93, s41, v93
    v_xor_b32 v94, s42, v94
    v_xor_b32 v95, s43, v95
    v_or3_b32 v1, v1, v92, v93
    v_or3_b32 v1, v1, v94, v95
    v_pk_add_f32 v[32:33], v[32:33], v[92:93]
    v_pk_add_f32 v[34:35], v[34:35], v[94:95]
    s_waitcnt vmcnt(4)
    v_xor_b32 v96, s40, v96
    v_xor_b32 v97, s41, v97
    v_xor_b32 v98, s42, v98
    v_xor_b32 v99, s43, v99
    v_or3_b32 v1, v1, v96, v97
    v_or3_b32 v1, v1, v98, v99
    v_and_b32 v1, 0xff, v1
    v_cmp_ne_u32 vcc, 0, v1
    v_pk_add_f32 v[32:33], v[32:33], v[96:97]
    v_pk_add_f32 v[34:35], v[34:35], v[98:99]
    s_nop 1
    v_permlane32_swap_b32 v32, v34
    v_permlane32_swap_b32 v33, v35
    v_pk_add_f32 v[32:33], v[32:33], v[34:35]
    s_cbranch_vccnz rt_136
redd_135:
    s_mov_b64 exec, s[68:69]
    global_store_dword v138, v172, s[72:73] offset:0 sc1
    s_mov_b64 exec, -1
    v_mov_b32 v34, v32
    v_mov_b32 v35, v33
    s_nop 0
    v_permlane16_swap_b32 v32, v34
    v_permlane16_swap_b32 v33, v35
    v_add_f32 v32, v32, v34
    v_add_f32 v33, v33, v35
    s_nop 0
    v_add_f32_dpp v32, v32, v32 row_ror:8 row_mask:0xf bank_mask:0xf
    v_add_f32_dpp v33, v33, v33 row_ror:8 row_mask:0xf bank_mask:0xf
    v_pk_add_f32 v[32:33], v[32:33], v[128:129]
    s_mov_b32 exec_lo, 0xff
    s_mov_b32 exec_hi, 0xff
    v_cvt_pk_bf16_f32 v32, v32, v33
    v_min_u32 v32, -2, v32
    s_cmp_eq_u32 s64, 0
    s_cbranch_scc1 ss_137
    global_store_dword v134, v32, s[30:31]
ssr_138:
    v_lshlrev_b32 v128, 16, v32
    v_and_b32 v129, 0xffff0000, v32
    s_mov_b64 exec, -1
    s_mov_b64 exec, 1
    ds_add_u32 v253, v225 offset:16
    s_mov_b64 exec, -1
    s_cmp_eq_u32 s32, 28
    s_cbranch_scc1 pv_139
pvr_140:
    s_mov_b32 s63, 1
    s_add_u32 s30, s30, 0x200000
    s_addc_u32 s31, s31, 0
    s_xor_b32 s36, s36, 2
    s_xor_b32 s37, s37, 2
    s_xor_b32 s38, s38, 2
    s_xor_b32 s39, s39, 2
    s_xor_b32 s40, s40, 2
    s_xor_b32 s41, s41, 2
    s_xor_b32 s42, s42, 2
    s_xor_b32 s43, s43, 2
    s_cmp_lt_u32 s32, 28
    s_cselect_b32 s67, 12, 8
lw_141:
    ds_read_b32 v4, v253 offset:52
    s_waitcnt lgkmcnt(0)
    v_cmp_gt_u32 vcc, s67, v4
    s_cbranch_vccnz rt_142
    s_mov_b32 exec_lo, 0xff
    s_mov_b32 exec_hi, 0x0
can_143:
    global_load_dword v68, v137, s[30:31] offset:0 sc1
    s_waitcnt vmcnt(0)
    v_cmp_ne_u32 vcc, s74, v68
    s_cbranch_vccnz rt_144
    s_mov_b64 exec, -1
    s_sleep 6
    s_barrier
lw_145:
    ds_read_b32 v4, v253 offset:4
    s_waitcnt lgkmcnt(0)
    v_cmp_gt_u32 vcc, 8, v4
    s_cbranch_vccnz rt_146
    s_sleep 18
    s_barrier
    s_sleep 2
    global_load_dwordx4 v[84:87], v140, s[30:31] sc1
    global_load_dwordx4 v[88:91], v140, s[30:31] offset:1024 sc1
    s_barrier
    global_load_dwordx4 v[68:71], v132, s[28:29] offset:0 sc1
    global_load_dwordx4 v[72:75], v132, s[28:29] offset:1024 sc1
    global_load_dwordx4 v[76:79], v132, s[28:29] offset:2048 sc1
    global_load_dwordx4 v[80:83], v132, s[28:29] offset:3072 sc1
red_147:
    global_load_dwordx4 v[84:87], v132, s[28:29] offset:0 sc1
    global_load_dwordx4 v[88:91], v132, s[28:29] offset:1024 sc1
    global_load_dwordx4 v[92:95], v132, s[28:29] offset:2048 sc1
    global_load_dwordx4 v[96:99], v132, s[28:29] offset:3072 sc1
    s_waitcnt vmcnt(7)
    v_xor_b32 v68, s36, v68
    v_xor_b32 v69, s37, v69
    v_xor_b32 v70, s38, v70
    v_xor_b32 v71, s39, v71
    v_or3_b32 v1, v68, v69, v70
    v_or_b32 v1, v1, v71
    s_waitcnt vmcnt(6)
    v_xor_b32 v72, s36, v72
    v_xor_b32 v73, s37, v73
    v_xor_b32 v74, s38, v74
    v_xor_b32 v75, s39, v75
    v_or3_b32 v1, v1, v72, v73
    v_or3_b32 v1, v1, v74, v75
    v_pk_add_f32 v[32:33], v[68:69], v[72:73]
    v_pk_add_f32 v[34:35], v[70:71], v[74:75]
    s_waitcnt vmcnt(5)
    v_xor_b32 v76, s36, v76
    v_xor_b32 v77, s37, v77
    v_xor_b32 v78, s38, v78
    v_xor_b32 v79, s39, v79
    v_or3_b32 v1, v1, v76, v77
    v_or3_b32 v1, v1, v78, v79
    v_pk_add_f32 v[32:33], v[32:33], v[76:77]
    v_pk_add_f32 v[34:35], v[34:35], v[78:79]
    s_waitcnt vmcnt(4)
    v_xor_b32 v80, s36, v80
    v_xor_b32 v81, s37, v81
    v_xor_b32 v82, s38, v82
    v_xor_b32 v83, s39, v83
    v_or3_b32 v1, v1, v80, v81
    v_or3_b32 v1, v1, v82, v83
    v_and_b32 v1, 0xff, v1
    v_cmp_ne_u32 vcc, 0, v1
    v_pk_add_f32 v[32:33], v[32:33], v[80:81]
    v_pk_add_f32 v[34:35], v[34:35], v[82:83]
    s_nop 1
    v_permlane32_swap_b32 v32, v34
    v_permlane32_swap_b32 v33, v35
    v_pk_add_f32 v[32:33], v[32:33], v[34:35]
    s_cbranch_vccz redd_148
    global_load_dwordx4 v[68:71], v132, s[28:29] offset:0 sc1
    global_load_dwordx4 v[72:75], v132, s[28:29] offset:1024 sc1
    global_load_dwordx4 v[76:79], v132, s[28:29] offset:2048 sc1
    global_load_dwordx4 v[80:83], v132, s[28:29] offset:3072 sc1
    s_waitcnt vmcnt(7)
    v_xor_b32 v84, s36, v84
    v_xor_b32 v85, s37, v85
    v_xor_b32 v86, s38, v86
    v_xor_b32 v87, s39, v87
    v_or3_b32 v1, v84, v85, v86
    v_or_b32 v1, v1, v87
    s_waitcnt vmcnt(6)
    v_xor_b32 v88, s36, v88
    v_xor_b32 v89, s37, v89
    v_xor_b32 v90, s38, v90
    v_xor_b32 v91, s39, v91
    v_or3_b32 v1, v1, v88, v89
    v_or3_b32 v1, v1, v90, v91
    v_pk_add_f32 v[32:33], v[84:85], v[88:89]
    v_pk_add_f32 v[34:35], v[86:87], v[90:91]
    s_waitcnt vmcnt(5)
    v_xor_b32 v92, s36, v92
    v_xor_b32 v93, s37, v93
    v_xor_b32 v94, s38, v94
    v_xor_b32 v95, s39, v95
    v_or3_b32 v1, v1, v92, v93
    v_or3_b32 v1, v1, v94, v95
    v_pk_add_f32 v[32:33], v[32:33], v[92:93]
    v_pk_add_f32 v[34:35], v[34:35], v[94:95]
    s_waitcnt vmcnt(4)
    v_xor_b32 v96, s36, v96
    v_xor_b32 v97, s37, v97
    v_xor_b32 v98, s38, v98
    v_xor_b32 v99, s39, v99
    v_or3_b32 v1, v1, v96, v97
    v_or3_b32 v1, v1, v98, v99
    v_and_b32 v1, 0xff, v1
    v_cmp_ne_u32 vcc, 0, v1
    v_pk_add_f32 v[32:33], v[32:33], v[96:97]
    v_pk_add_f32 v[34:35], v[34:35], v[98:99]
    s_nop 1
    v_permlane32_swap_b32 v32, v34
    v_permlane32_swap_b32 v33, v35
    v_pk_add_f32 v[32:33], v[32:33], v[34:35]
    s_cbranch_vccnz rt_149
redd_148:
    s_mov_b64 exec, s[68:69]
    global_store_dword v138, v172, s[30:31] offset:1024 sc1
    s_mov_b64 exec, -1
    v_mov_b32 v34, v32
    v_mov_b32 v35, v33
    s_nop 0
    v_permlane16_swap_b32 v32, v34
    v_permlane16_swap_b32 v33, v35
    v_add_f32 v32, v32, v34
    v_add_f32 v33, v33, v35
    s_nop 0
    v_add_f32_dpp v32, v32, v32 row_ror:8 row_mask:0xf bank_mask:0xf
    v_add_f32_dpp v33, v33, v33 row_ror:8 row_mask:0xf bank_mask:0xf
    v_pk_add_f32 v[32:33], v[32:33], v[128:129]
    s_mov_b32 exec_lo, 0xff
    s_mov_b32 exec_hi, 0xff
    v_cvt_pk_bf16_f32 v32, v32, v33
    v_min_u32 v32, -2, v32
    s_cmp_eq_u32 s64, 0
    s_cbranch_scc1 ss_150
    global_store_dword v133, v32, s[30:31]
ssr_151:
    v_lshlrev_b32 v128, 16, v32
    v_and_b32 v129, 0xffff0000, v32
    s_mov_b64 exec, -1
    s_barrier
    s_cmp_eq_u32 s32, 28
    s_cbranch_scc1 pv_152
pvr_153:
    v_pk_add_f32 v[128:129], v[128:129], v[130:131]
    s_cmp_lt_u32 s32, 28
    s_cbranch_scc1 w5_154
w5r_155:
    s_barrier
    s_barrier
    global_load_dwordx4 v[68:71], v132, s[28:29] offset:0 sc1
    global_load_dwordx4 v[72:75], v132, s[28:29] offset:1024 sc1
    global_load_dwordx4 v[76:79], v132, s[28:29] offset:2048 sc1
    v_mov_b32 v80, s40
    v_mov_b32 v81, s41
    v_mov_b32 v82, s42
    v_mov_b32 v83, s43
    s_mov_b32 exec_lo, 0xffffffff
    s_mov_b32 exec_hi, 0x0
    global_load_dwordx4 v[80:83], v132, s[28:29] offset:3072 sc1
    s_mov_b64 exec, -1
red_156:
    global_load_dwordx4 v[84:87], v132, s[28:29] offset:0 sc1
    global_load_dwordx4 v[88:91], v132, s[28:29] offset:1024 sc1
    global_load_dwordx4 v[92:95], v132, s[28:29] offset:2048 sc1
    v_mov_b32 v96, s40
    v_mov_b32 v97, s41
    v_mov_b32 v98, s42
    v_mov_b32 v99, s43
    s_mov_b32 exec_lo, 0xffffffff
    s_mov_b32 exec_hi, 0x0
    global_load_dwordx4 v[96:99], v132, s[28:29] offset:3072 sc1
    s_mov_b64 exec, -1
    s_waitcnt vmcnt(7)
    v_xor_b32 v68, s40, v68
    v_xor_b32 v69, s41, v69
    v_xor_b32 v70, s42, v70
    v_xor_b32 v71, s43, v71
    v_or3_b32 v1, v68, v69, v70
    v_or_b32 v1, v1, v71
    s_waitcnt vmcnt(6)
    v_xor_b32 v72, s40, v72
    v_xor_b32 v73, s41, v73
    v_xor_b32 v74, s42, v74
    v_xor_b32 v75, s43, v75
    v_or3_b32 v1, v1, v72, v73
    v_or3_b32 v1, v1, v74, v75
    v_pk_add_f32 v[32:33], v[68:69], v[72:73]
    v_pk_add_f32 v[34:35], v[70:71], v[74:75]
    s_waitcnt vmcnt(5)
    v_xor_b32 v76, s40, v76
    v_xor_b32 v77, s41, v77
    v_xor_b32 v78, s42, v78
    v_xor_b32 v79, s43, v79
    v_or3_b32 v1, v1, v76, v77
    v_or3_b32 v1, v1, v78, v79
    v_pk_add_f32 v[32:33], v[32:33], v[76:77]
    v_pk_add_f32 v[34:35], v[34:35], v[78:79]
    s_waitcnt vmcnt(4)
    v_xor_b32 v80, s40, v80
    v_xor_b32 v81, s41, v81
    v_xor_b32 v82, s42, v82
    v_xor_b32 v83, s43, v83
    v_or3_b32 v1, v1, v80, v81
    v_or3_b32 v1, v1, v82, v83
    v_and_b32 v1, 0xff, v1
    v_cmp_ne_u32 vcc, 0, v1
    v_pk_add_f32 v[32:33], v[32:33], v[80:81]
    v_pk_add_f32 v[34:35], v[34:35], v[82:83]
    s_nop 1
    v_permlane32_swap_b32 v32, v34
    v_permlane32_swap_b32 v33, v35
    v_pk_add_f32 v[32:33], v[32:33], v[34:35]
    s_cbranch_vccz redd_157
    global_load_dwordx4 v[68:71], v132, s[28:29] offset:0 sc1
    global_load_dwordx4 v[72:75], v132, s[28:29] offset:1024 sc1
    global_load_dwordx4 v[76:79], v132, s[28:29] offset:2048 sc1
    v_mov_b32 v80, s40
    v_mov_b32 v81, s41
    v_mov_b32 v82, s42
    v_mov_b32 v83, s43
    s_mov_b32 exec_lo, 0xffffffff
    s_mov_b32 exec_hi, 0x0
    global_load_dwordx4 v[80:83], v132, s[28:29] offset:3072 sc1
    s_mov_b64 exec, -1
    s_waitcnt vmcnt(7)
    v_xor_b32 v84, s40, v84
    v_xor_b32 v85, s41, v85
    v_xor_b32 v86, s42, v86
    v_xor_b32 v87, s43, v87
    v_or3_b32 v1, v84, v85, v86
    v_or_b32 v1, v1, v87
    s_waitcnt vmcnt(6)
    v_xor_b32 v88, s40, v88
    v_xor_b32 v89, s41, v89
    v_xor_b32 v90, s42, v90
    v_xor_b32 v91, s43, v91
    v_or3_b32 v1, v1, v88, v89
    v_or3_b32 v1, v1, v90, v91
    v_pk_add_f32 v[32:33], v[84:85], v[88:89]
    v_pk_add_f32 v[34:35], v[86:87], v[90:91]
    s_waitcnt vmcnt(5)
    v_xor_b32 v92, s40, v92
    v_xor_b32 v93, s41, v93
    v_xor_b32 v94, s42, v94
    v_xor_b32 v95, s43, v95
    v_or3_b32 v1, v1, v92, v93
    v_or3_b32 v1, v1, v94, v95
    v_pk_add_f32 v[32:33], v[32:33], v[92:93]
    v_pk_add_f32 v[34:35], v[34:35], v[94:95]
    s_waitcnt vmcnt(4)
    v_xor_b32 v96, s40, v96
    v_xor_b32 v97, s41, v97
    v_xor_b32 v98, s42, v98
    v_xor_b32 v99, s43, v99
    v_or3_b32 v1, v1, v96, v97
    v_or3_b32 v1, v1, v98, v99
    v_and_b32 v1, 0xff, v1
    v_cmp_ne_u32 vcc, 0, v1
    v_pk_add_f32 v[32:33], v[32:33], v[96:97]
    v_pk_add_f32 v[34:35], v[34:35], v[98:99]
    s_nop 1
    v_permlane32_swap_b32 v32, v34
    v_permlane32_swap_b32 v33, v35
    v_pk_add_f32 v[32:33], v[32:33], v[34:35]
    s_cbranch_vccnz rt_158
redd_157:
    v_mov_b32 v34, v32
    v_mov_b32 v35, v33
    s_nop 0
    v_permlane16_swap_b32 v32, v34
    v_permlane16_swap_b32 v33, v35
    v_add_f32 v32, v32, v34
    v_add_f32 v33, v33, v35
    s_nop 0
    v_add_f32_dpp v32, v32, v32 row_ror:8 row_mask:0xf bank_mask:0xf
    v_add_f32_dpp v33, v33, v33 row_ror:8 row_mask:0xf bank_mask:0xf
    v_pk_add_f32 v[32:33], v[32:33], v[128:129]
    s_mov_b32 exec_lo, 0xff
    s_mov_b32 exec_hi, 0xff
    v_cvt_pk_bf16_f32 v32, v32, v33
    global_store_dword v135, v32, s[24:25]
    s_mov_b64 exec, -1
    s_cmp_eq_u32 s2, 0
    s_cbranch_scc1 ep_159
epr_160:
    s_endpgm
pv_97:
pv_161:
    global_load_dwordx4 v[84:87], v11, s[4:5]
    global_load_dwordx4 v[88:91], v11, s[4:5] offset:16
    s_waitcnt vmcnt(0)
    v_mov_b32 v92, 0
    v_mov_b32 v94, 0
    v_mov_b32 v96, 0x3f803f80
    v_dot2_f32_bf16 v92, v84, v84, v92
    v_dot2_f32_bf16 v94, v84, v96, v94
    v_dot2_f32_bf16 v92, v85, v85, v92
    v_dot2_f32_bf16 v94, v85, v96, v94
    v_dot2_f32_bf16 v92, v86, v86, v92
    v_dot2_f32_bf16 v94, v86, v96, v94
    v_dot2_f32_bf16 v92, v87, v87, v92
    v_dot2_f32_bf16 v94, v87, v96, v94
    v_dot2_f32_bf16 v92, v88, v88, v92
    v_dot2_f32_bf16 v94, v88, v96, v94
    v_dot2_f32_bf16 v92, v89, v89, v92
    v_dot2_f32_bf16 v94, v89, v96, v94
    v_dot2_f32_bf16 v92, v90, v90, v92
    v_dot2_f32_bf16 v94, v90, v96, v94
    v_dot2_f32_bf16 v92, v91, v91, v92
    v_dot2_f32_bf16 v94, v91, v96, v94
    s_nop 1
    v_add_f32_dpp v92, v92, v92 row_ror:8 row_mask:0xf bank_mask:0xf
    v_add_f32_dpp v94, v94, v94 row_ror:8 row_mask:0xf bank_mask:0xf
    v_mov_b32 v93, v92
    v_mov_b32 v95, v94
    s_nop 0
    v_permlane16_swap_b32 v92, v93
    v_permlane16_swap_b32 v94, v95
    v_add_f32 v92, v92, v93
    v_add_f32 v94, v94, v95
    v_mov_b32 v93, v92
    v_mov_b32 v95, v94
    s_nop 0
    v_permlane32_swap_b32 v92, v93
    v_permlane32_swap_b32 v94, v95
    v_add_f32 v92, v92, v93
    v_add_f32 v94, v94, v95
    v_mov_b32 v93, s74
    v_mov_b32 v95, s74
    s_mov_b32 exec_lo, 0xff
    s_mov_b32 exec_hi, 0x0
    global_store_dwordx4 v139, v[92:95], s[28:29] offset:1024 sc1
    s_mov_b64 exec, -1
    s_nop 4
    s_branch pvr_98
e_99:
    global_store_dwordx4 v164, v[168:171], s[28:29] sc1
    global_store_dwordx4 v165, v[168:171], s[28:29] sc1
    s_nop 4
    s_branch er_100
rt_102:
    s_sleep 1
    s_add_u32 s65, s65, 1
    s_cmp_lt_u32 s65, 40000
    s_cbranch_scc1 lw_101
    s_endpgm
rt_104:
    s_sleep 16
    s_add_u32 s65, s65, 1
    s_cmp_lt_u32 s65, 40000
    s_cbranch_scc1 xw_103
    s_endpgm
rt_106:
    s_sleep 1
    s_add_u32 s65, s65, 1
    s_cmp_lt_u32 s65, 40000
    s_cbranch_scc1 lw_105
    s_endpgm
e_107:
    global_store_dwordx4 v164, v[168:171], s[72:73] sc1
    global_store_dwordx4 v165, v[168:171], s[72:73] sc1
    s_nop 4
    s_branch er_108
rt_110:
    s_sleep 2
    s_add_u32 s65, s65, 1
    s_cmp_lt_u32 s65, 40000
    s_cbranch_scc1 xw_109
    s_endpgm
ss_111:
    global_store_dword v133, v168, s[28:29] sc1
    s_nop 4
    s_branch ssr_112
ss_113:
    global_store_dword v134, v168, s[28:29] sc1
    s_nop 4
    s_branch ssr_114
ss_115:
    global_store_dword v3, v168, s[28:29] sc1
    s_nop 4
    s_branch ssr_116
rt_118:
    s_sleep 1
    s_add_u32 s65, s65, 1
    s_cmp_lt_u32 s65, 40000
    s_cbranch_scc1 lw_117
    s_endpgm
rt_120:
    s_sleep 16
    s_add_u32 s65, s65, 1
    s_cmp_lt_u32 s65, 40000
    s_cbranch_scc1 can_119
    s_endpgm
rt_122:
    s_sleep 1
    s_add_u32 s65, s65, 1
    s_cmp_lt_u32 s65, 40000
    s_cbranch_scc1 lw_121
    s_endpgm
rt_125:
    s_add_u32 s65, s65, 1
    s_cmp_lt_u32 s65, 40000
    s_cbranch_scc1 red_123
    s_endpgm
ss_126:
    global_store_dword v133, v32, s[30:31] sc1
    s_nop 4
    s_branch ssr_127
pv_128:
pv_162:
    global_load_dwordx4 v[84:87], v140, s[30:31] sc1
    global_load_dwordx4 v[88:91], v140, s[30:31] offset:1024 sc1
    s_waitcnt vmcnt(0)
    v_mov_b32 v92, 0
    v_mov_b32 v94, 0
    v_mov_b32 v96, 0x3f803f80
    v_max3_u32 v1, v84, v85, v86
    v_max3_u32 v1, v1, v87, v88
    v_max3_u32 v1, v1, v89, v90
    v_max_u32 v1, v1, v91
    v_cmp_eq_u32 vcc, -1, v1
    v_dot2_f32_bf16 v92, v84, v84, v92
    v_dot2_f32_bf16 v94, v84, v96, v94
    v_dot2_f32_bf16 v92, v85, v85, v92
    v_dot2_f32_bf16 v94, v85, v96, v94
    v_dot2_f32_bf16 v92, v86, v86, v92
    v_dot2_f32_bf16 v94, v86, v96, v94
    v_dot2_f32_bf16 v92, v87, v87, v92
    v_dot2_f32_bf16 v94, v87, v96, v94
    v_dot2_f32_bf16 v92, v88, v88, v92
    v_dot2_f32_bf16 v94, v88, v96, v94
    v_dot2_f32_bf16 v92, v89, v89, v92
    v_dot2_f32_bf16 v94, v89, v96, v94
    v_dot2_f32_bf16 v92, v90, v90, v92
    v_dot2_f32_bf16 v94, v90, v96, v94
    v_dot2_f32_bf16 v92, v91, v91, v92
    v_dot2_f32_bf16 v94, v91, v96, v94
    s_cbranch_vccnz rt_163
    s_nop 0
    v_add_f32_dpp v92, v92, v92 row_ror:8 row_mask:0xf bank_mask:0xf
    v_add_f32_dpp v94, v94, v94 row_ror:8 row_mask:0xf bank_mask:0xf
    v_mov_b32 v93, v92
    v_mov_b32 v95, v94
    s_nop 0
    v_permlane16_swap_b32 v92, v93
    v_permlane16_swap_b32 v94, v95
    v_add_f32 v92, v92, v93
    v_add_f32 v94, v94, v95
    v_mov_b32 v93, v92
    v_mov_b32 v95, v94
    s_nop 0
    v_permlane32_swap_b32 v92, v93
    v_permlane32_swap_b32 v94, v95
    v_add_f32 v92, v92, v93
    v_add_f32 v94, v94, v95
    v_mov_b32 v93, s74
    v_mov_b32 v95, s74
    s_mov_b32 exec_lo, 0xff
    s_mov_b32 exec_hi, 0x0
    global_store_dwordx4 v139, v[92:95], s[30:31] offset:0 sc1
    s_mov_b64 exec, -1
    s_nop 4
    s_branch pvr_129
w5_130:
lw_164:
    ds_read_b32 v4, v253 offset:52
    s_waitcnt lgkmcnt(0)
    v_cmp_gt_u32 vcc, 8, v4
    s_cbranch_vccnz rt_165
    s_mov_b32 exec_lo, 0xff
    s_mov_b32 exec_hi, 0x0
can_166:
    global_load_dword v68, v137, s[30:31] offset:1024 sc1
    s_waitcnt vmcnt(0)
    v_cmp_ne_u32 vcc, s74, v68
    s_cbranch_vccnz rt_167
    s_mov_b64 exec, -1
    s_sleep 4
    s_nop 4
    s_branch w5r_131
rt_133:
    s_sleep 1
    s_add_u32 s65, s65, 1
    s_cmp_lt_u32 s65, 40000
    s_cbranch_scc1 lw_132
    s_endpgm
rt_136:
    s_add_u32 s65, s65, 1
    s_cmp_lt_u32 s65, 40000
    s_cbranch_scc1 red_134
    s_endpgm
ss_137:
    global_store_dword v134, v32, s[30:31] sc1
    s_nop 4
    s_branch ssr_138
pv_139:
pv_168:
    global_load_dwordx4 v[84:87], v141, s[30:31] sc1
    global_load_dwordx4 v[88:91], v141, s[30:31] offset:1024 sc1
    s_waitcnt vmcnt(0)
    v_mov_b32 v92, 0
    v_mov_b32 v94, 0
    v_mov_b32 v96, 0x3f803f80
    v_max3_u32 v1, v84, v85, v86
    v_max3_u32 v1, v1, v87, v88
    v_max3_u32 v1, v1, v89, v90
    v_max_u32 v1, v1, v91
    v_cmp_eq_u32 vcc, -1, v1
    v_dot2_f32_bf16 v92, v84, v84, v92
    v_dot2_f32_bf16 v94, v84, v96, v94
    v_dot2_f32_bf16 v92, v85, v85, v92
    v_dot2_f32_bf16 v94, v85, v96, v94
    v_dot2_f32_bf16 v92, v86, v86, v92
    v_dot2_f32_bf16 v94, v86, v96, v94
    v_dot2_f32_bf16 v92, v87, v87, v92
    v_dot2_f32_bf16 v94, v87, v96, v94
    v_dot2_f32_bf16 v92, v88, v88, v92
    v_dot2_f32_bf16 v94, v88, v96, v94
    v_dot2_f32_bf16 v92, v89, v89, v92
    v_dot2_f32_bf16 v94, v89, v96, v94
    v_dot2_f32_bf16 v92, v90, v90, v92
    v_dot2_f32_bf16 v94, v90, v96, v94
    v_dot2_f32_bf16 v92, v91, v91, v92
    v_dot2_f32_bf16 v94, v91, v96, v94
    s_cbranch_vccnz rt_169
    s_nop 0
    v_add_f32_dpp v92, v92, v92 row_ror:8 row_mask:0xf bank_mask:0xf
    v_add_f32_dpp v94, v94, v94 row_ror:8 row_mask:0xf bank_mask:0xf
    v_mov_b32 v93, v92
    v_mov_b32 v95, v94
    s_nop 0
    v_permlane16_swap_b32 v92, v93
    v_permlane16_swap_b32 v94, v95
    v_add_f32 v92, v92, v93
    v_add_f32 v94, v94, v95
    v_mov_b32 v93, v92
    v_mov_b32 v95, v94
    s_nop 0
    v_permlane32_swap_b32 v92, v93
    v_permlane32_swap_b32 v94, v95
    v_add_f32 v92, v92, v93
    v_add_f32 v94, v94, v95
    v_mov_b32 v93, s74
    v_mov_b32 v95, s74
    s_mov_b32 exec_lo, 0xff
    s_mov_b32 exec_hi, 0x0
    global_store_dwordx4 v139, v[92:95], s[72:73] offset:1024 sc1
    s_mov_b64 exec, -1
    s_nop 4
    s_branch pvr_140
rt_142:
    s_add_u32 s65, s65, 1
    s_cmp_lt_u32 s65, 40000
    s_cbranch_scc1 lw_141
    s_endpgm
rt_144:
    s_add_u32 s65, s65, 1
    s_cmp_lt_u32 s65, 40000
    s_cbranch_scc1 can_143
    s_endpgm
rt_146:
    s_add_u32 s65, s65, 1
    s_cmp_lt_u32 s65, 40000
    s_cbranch_scc1 lw_145
    s_endpgm
rt_149:
    s_add_u32 s65, s65, 1
    s_cmp_lt_u32 s65, 40000
    s_cbranch_scc1 red_147
    s_endpgm
ss_150:
    global_store_dword v133, v32, s[30:31] sc1
    s_nop 4
    s_branch ssr_151
pv_152:
pv_170:
    global_load_dwordx4 v[84:87], v140, s[30:31] sc1
    global_load_dwordx4 v[88:91], v140, s[30:31] offset:1024 sc1
    s_waitcnt vmcnt(0)
    v_mov_b32 v92, 0
    v_mov_b32 v94, 0
    v_mov_b32 v96, 0x3f803f80
    v_max3_u32 v1, v84, v85, v86
    v_max3_u32 v1, v1, v87, v88
    v_max3_u32 v1, v1, v89, v90
    v_max_u32 v1, v1, v91
    v_cmp_eq_u32 vcc, -1, v1
    v_dot2_f32_bf16 v92, v84, v84, v92
    v_dot2_f32_bf16 v94, v84, v96, v94
    v_dot2_f32_bf16 v92, v85, v85, v92
    v_dot2_f32_bf16 v94, v85, v96, v94
    v_dot2_f32_bf16 v92, v86, v86, v92
    v_dot2_f32_bf16 v94, v86, v96, v94
    v_dot2_f32_bf16 v92, v87, v87, v92
    v_dot2_f32_bf16 v94, v87, v96, v94
    v_dot2_f32_bf16 v92, v88, v88, v92
    v_dot2_f32_bf16 v94, v88, v96, v94
    v_dot2_f32_bf16 v92, v89, v89, v92
    v_dot2_f32_bf16 v94, v89, v96, v94
    v_dot2_f32_bf16 v92, v90, v90, v92
    v_dot2_f32_bf16 v94, v90, v96, v94
    v_dot2_f32_bf16 v92, v91, v91, v92
    v_dot2_f32_bf16 v94, v91, v96, v94
    s_cbranch_vccnz rt_171
    s_nop 0
    v_add_f32_dpp v92, v92, v92 row_ror:8 row_mask:0xf bank_mask:0xf
    v_add_f32_dpp v94, v94, v94 row_ror:8 row_mask:0xf bank_mask:0xf
    v_mov_b32 v93, v92
    v_mov_b32 v95, v94
    s_nop 0
    v_permlane16_swap_b32 v92, v93
    v_permlane16_swap_b32 v94, v95
    v_add_f32 v92, v92, v93
    v_add_f32 v94, v94, v95
    v_mov_b32 v93, v92
    v_mov_b32 v95, v94
    s_nop 0
    v_permlane32_swap_b32 v92, v93
    v_permlane32_swap_b32 v94, v95
    v_add_f32 v92, v92, v93
    v_add_f32 v94, v94, v95
    v_mov_b32 v93, s74
    v_mov_b32 v95, s74
    s_mov_b32 exec_lo, 0xff
    s_mov_b32 exec_hi, 0x0
    global_store_dwordx4 v139, v[92:95], s[30:31] offset:0 sc1
    s_mov_b64 exec, -1
    s_nop 4
    s_branch pvr_153
w5_154:
lw_172:
    ds_read_b32 v4, v253 offset:52
    s_waitcnt lgkmcnt(0)
    v_cmp_gt_u32 vcc, 16, v4
    s_cbranch_vccnz rt_173
    s_mov_b32 exec_lo, 0xff
    s_mov_b32 exec_hi, 0x0
can_174:
    global_load_dword v68, v137, s[30:31] offset:1024 sc1
    s_waitcnt vmcnt(0)
    v_cmp_ne_u32 vcc, s74, v68
    s_cbranch_vccnz rt_175
    s_mov_b64 exec, -1
    s_sleep 3
    s_nop 4
    s_branch w5r_155
rt_158:
    s_add_u32 s65, s65, 1
    s_cmp_lt_u32 s65, 40000
    s_cbranch_scc1 red_156
    s_endpgm
ep_159:
    s_add_u32 s44, s62, 1
    v_mov_b32 v1, s44
    v_mov_b32 v2, 0x541000
    s_mov_b64 exec, 1
    global_store_dword v2, v1, s[28:29]
    s_mov_b64 exec, -1
    s_nop 4
    s_branch epr_160
rt_163:
    s_add_u32 s65, s65, 1
    s_cmp_lt_u32 s65, 40000
    s_cbranch_scc1 pv_162
    s_endpgm
rt_165:
    s_add_u32 s65, s65, 1
    s_cmp_lt_u32 s65, 40000
    s_cbranch_scc1 lw_164
    s_endpgm
rt_167:
    s_add_u32 s65, s65, 1
    s_cmp_lt_u32 s65, 40000
    s_cbranch_scc1 can_166
    s_endpgm
rt_169:
    s_add_u32 s65, s65, 1
    s_cmp_lt_u32 s65, 40000
    s_cbranch_scc1 pv_168
    s_endpgm
rt_171:
    s_add_u32 s65, s65, 1
    s_cmp_lt_u32 s65, 40000
    s_cbranch_scc1 pv_170
    s_endpgm
rt_173:
    s_add_u32 s65, s65, 1
    s_cmp_lt_u32 s65, 40000
    s_cbranch_scc1 lw_172
    s_endpgm
rt_175:
    s_add_u32 s65, s65, 1
    s_cmp_lt_u32 s65, 40000
    s_cbranch_scc1 can_174
    s_endpgm
L_loader:
    s_setprio 3
    v_lshrrev_b32 v1, 4, v0
    v_and_b32 v2, 15, v0
    v_lshlrev_b32 v3, 2, v1
    v_xor_b32 v2, v2, v3
    v_lshlrev_b32 v2, 4, v2
    s_mov_b32 s44, 8192
    v_mad_u32_u24 v9, v1, s44, v2
    s_mov_b32 s44, 256
    v_mad_u32_u24 v10, v1, s44, v2
    s_mov_b32 s44, 2048
    v_mad_u32_u24 v11, v1, s44, v2
    s_mov_b32 s44, 7168
    v_mad_u32_u24 v12, v1, s44, v2
    s_lshl_b32 s44, s3, 20
    s_lshl_b32 s45, s32, 8
    s_add_u32 s44, s44, s45
    s_waitcnt lgkmcnt(0)
    s_add_u32 s10, s10, s44
    s_addc_u32 s11, s11, 0
    s_mov_b32 m0, 0
    s_nop 0
    global_load_lds_dwordx4 v9, s[10:11] nt
    s_mov_b32 m0, 1024
    s_add_u32 s10, s10, 32768
    s_addc_u32 s11, s11, 0
    global_load_lds_dwordx4 v9, s[10:11] nt
    s_mov_b32 m0, 2048
    s_add_u32 s10, s10, 32768
    s_addc_u32 s11, s11, 0
    global_load_lds_dwordx4 v9, s[10:11] nt
    s_mov_b32 m0, 3072
    s_add_u32 s10, s10, 32768
    s_addc_u32 s11, s11, 0
    global_load_lds_dwordx4 v9, s[10:11] nt
    s_mov_b32 m0, 4096
    s_add_u32 s10, s10, 32768
    s_addc_u32 s11, s11, 0
    global_load_lds_dwordx4 v9, s[10:11] nt
    s_mov_b32 m0, 5120
    s_add_u32 s10, s10, 32768
    s_addc_u32 s11, s11, 0
    global_load_lds_dwordx4 v9, s[10:11] nt
    s_mov_b32 m0, 6144
    s_add_u32 s10, s10, 32768
    s_addc_u32 s11, s11, 0
    global_load_lds_dwordx4 v9, s[10:11] nt
    s_mov_b32 m0, 7168
    s_add_u32 s10, s10, 32768
    s_addc_u32 s11, s11, 0
    global_load_lds_dwordx4 v9, s[10:11] nt
    s_mov_b32 m0, 8192
    s_add_u32 s10, s10, 32768
    s_addc_u32 s11, s11, 0
    global_load_lds_dwordx4 v9, s[10:11] nt
    s_mov_b32 m0, 9216
    s_add_u32 s10, s10, 32768
    s_addc_u32 s11, s11, 0
    global_load_lds_dwordx4 v9, s[10:11] nt
    s_mov_b32 m0, 10240
    s_add_u32 s10, s10, 32768
    s_addc_u32 s11, s11, 0
    global_load_lds_dwordx4 v9, s[10:11] nt
    s_mov_b32 m0, 11264
    s_add_u32 s10, s10, 32768
    s_addc_u32 s11, s11, 0
    global_load_lds_dwordx4 v9, s[10:11] nt
    s_mov_b32 m0, 12288
    s_add_u32 s10, s10, 32768
    s_addc_u32 s11, s11, 0
    global_load_lds_dwordx4 v9, s[10:11] nt
    s_mov_b32 m0, 13312
    s_add_u32 s10, s10, 32768
    s_addc_u32 s11, s11, 0
    global_load_lds_dwordx4 v9, s[10:11] nt
    s_mov_b32 m0, 14336
    s_add_u32 s10, s10, 32768
    s_addc_u32 s11, s11, 0
    global_load_lds_dwordx4 v9, s[10:11] nt
    s_mov_b32 m0, 15360
    s_add_u32 s10, s10, 32768
    s_addc_u32 s11, s11, 0
    global_load_lds_dwordx4 v9, s[10:11] nt
    s_mov_b32 m0, 16384
    s_add_u32 s10, s10, 32768
    s_addc_u32 s11, s11, 0
    global_load_lds_dwordx4 v9, s[10:11] nt
    s_mov_b32 m0, 17408
    s_add_u32 s10, s10, 32768
    s_addc_u32 s11, s11, 0
    global_load_lds_dwordx4 v9, s[10:11] nt
    s_mov_b32 m0, 18432
    s_add_u32 s10, s10, 32768
    s_addc_u32 s11, s11, 0
    global_load_lds_dwordx4 v9, s[10:11] nt
    s_mov_b32 m0, 19456
    s_add_u32 s10, s10, 32768
    s_addc_u32 s11, s11, 0
    global_load_lds_dwordx4 v9, s[10:11] nt
    s_mov_b32 m0, 20480
    s_add_u32 s10, s10, 32768
    s_addc_u32 s11, s11, 0
    global_load_lds_dwordx4 v9, s[10:11] nt
    s_mov_b32 m0, 21504
    s_add_u32 s10, s10, 32768
    s_addc_u32 s11, s11, 0
    global_load_lds_dwordx4 v9, s[10:11] nt
    s_mov_b32 m0, 22528
    s_add_u32 s10, s10, 32768
    s_addc_u32 s11, s11, 0
    global_load_lds_dwordx4 v9, s[10:11] nt
    s_mov_b32 m0, 23552
    s_add_u32 s10, s10, 32768
    s_addc_u32 s11, s11, 0
    global_load_lds_dwordx4 v9, s[10:11] nt
    s_mov_b32 m0, 24576
    s_add_u32 s10, s10, 32768
    s_addc_u32 s11, s11, 0
    global_load_lds_dwordx4 v9, s[10:11] nt
    s_mov_b32 m0, 25600
    s_add_u32 s10, s10, 32768
    s_addc_u32 s11, s11, 0
    global_load_lds_dwordx4 v9, s[10:11] nt
    s_mov_b32 m0, 26624
    s_add_u32 s10, s10, 32768
    s_addc_u32 s11, s11, 0
    global_load_lds_dwordx4 v9, s[10:11] nt
    s_mov_b32 m0, 27648
    s_add_u32 s10, s10, 32768
    s_addc_u32 s11, s11, 0
    global_load_lds_dwordx4 v9, s[10:11] nt
    s_mov_b32 m0, 28672
    s_add_u32 s10, s10, 32768
    s_addc_u32 s11, s11, 0
    global_load_lds_dwordx4 v9, s[10:11] nt
    s_mov_b32 m0, 29696
    s_add_u32 s10, s10, 32768
    s_addc_u32 s11, s11, 0
    global_load_lds_dwordx4 v9, s[10:11] nt
    s_mov_b32 m0, 30720
    s_add_u32 s10, s10, 32768
    s_addc_u32 s11, s11, 0
    global_load_lds_dwordx4 v9, s[10:11] nt
    s_mov_b32 m0, 31744
    s_add_u32 s10, s10, 32768
    s_addc_u32 s11, s11, 0
    global_load_lds_dwordx4 v9, s[10:11] nt
    s_lshl_b32 s44, s3, 22
    s_lshl_b32 s45, s33, 20
    s_add_u32 s44, s44, s45
    s_lshl_b32 s45, s34, 15
    s_add_u32 s44, s44, s45
    s_add_u32 s44, s44, 0xc0000
    s_add_u32 s6, s6, s44
    s_addc_u32 s7, s7, 0
    s_lshl_b32 s44, s3, 22
    s_lshl_b32 s45, s33, 20
    s_add_u32 s44, s44, s45
    s_lshl_b32 s45, s34, 15
    s_add_u32 s44, s44, s45
    s_add_u32 s44, s44, 0xc0000
    s_add_u32 s8, s8, s44
    s_addc_u32 s9, s9, 0
    s_lshl_b32 s44, s32, 18
    s_lshl_b32 s45, s3, 8
    s_add_u32 s44, s44, s45
    s_add_u32 s12, s12, s44
    s_addc_u32 s13, s13, 0
    s_mul_i32 s44, s3, 917504
    s_lshl_b32 s45, s32, 8
    s_add_u32 s44, s44, s45
    s_add_u32 s16, s16, s44
    s_addc_u32 s17, s17, 0
    s_lshl_b32 s44, s32, 18
    s_lshl_b32 s45, s3, 8
    s_add_u32 s44, s44, s45
    s_add_u32 s20, s20, s44
    s_addc_u32 s21, s21, 0
    s_barrier
    s_waitcnt vmcnt(10)
    ds_write_b32 v253, v225 offset:48
    s_mov_b32 m0, 32768
    s_nop 0
    global_load_lds_dwordx4 v10, s[6:7] nt
    s_mov_b32 m0, 33792
    s_add_u32 s6, s6, 1024
    s_addc_u32 s7, s7, 0
    global_load_lds_dwordx4 v10, s[6:7] nt
    s_mov_b32 m0, 34816
    s_add_u32 s6, s6, 1024
    s_addc_u32 s7, s7, 0
    global_load_lds_dwordx4 v10, s[6:7] nt
    s_mov_b32 m0, 35840
    s_add_u32 s6, s6, 1024
    s_addc_u32 s7, s7, 0
    global_load_lds_dwordx4 v10, s[6:7] nt
    s_mov_b32 m0, 36864
    s_add_u32 s6, s6, 1024
    s_addc_u32 s7, s7, 0
    global_load_lds_dwordx4 v10, s[6:7] nt
    s_mov_b32 m0, 37888
    s_add_u32 s6, s6, 1024
    s_addc_u32 s7, s7, 0
    global_load_lds_dwordx4 v10, s[6:7] nt
    s_mov_b32 m0, 38912
    s_add_u32 s6, s6, 1024
    s_addc_u32 s7, s7, 0
    global_load_lds_dwordx4 v10, s[6:7] nt
    s_mov_b32 m0, 39936
    s_add_u32 s6, s6, 1024
    s_addc_u32 s7, s7, 0
    global_load_lds_dwordx4 v10, s[6:7] nt
    s_waitcnt vmcnt(8)
    ds_write_b32 v253, v225 offset:64
    s_waitcnt vmcnt(27)
    s_mov_b32 m0, 40960
    s_add_u32 s6, s6, 1024
    s_addc_u32 s7, s7, 0
    global_load_lds_dwordx4 v10, s[6:7] nt
    s_waitcnt vmcnt(27)
    s_mov_b32 m0, 41984
    s_add_u32 s6, s6, 1024
    s_addc_u32 s7, s7, 0
    global_load_lds_dwordx4 v10, s[6:7] nt
    s_waitcnt vmcnt(27)
    s_mov_b32 m0, 43008
    s_add_u32 s6, s6, 1024
    s_addc_u32 s7, s7, 0
    global_load_lds_dwordx4 v10, s[6:7] nt
    s_waitcnt vmcnt(27)
    s_mov_b32 m0, 44032
    s_add_u32 s6, s6, 1024
    s_addc_u32 s7, s7, 0
    global_load_lds_dwordx4 v10, s[6:7] nt
    s_waitcnt vmcnt(27)
    s_mov_b32 m0, 45056
    s_add_u32 s6, s6, 1024
    s_addc_u32 s7, s7, 0
    global_load_lds_dwordx4 v10, s[6:7] nt
    s_waitcnt vmcnt(27)
    s_mov_b32 m0, 46080
    s_add_u32 s6, s6, 1024
    s_addc_u32 s7, s7, 0
    global_load_lds_dwordx4 v10, s[6:7] nt
    s_waitcnt vmcnt(27)
    s_mov_b32 m0, 47104
    s_add_u32 s6, s6, 1024
    s_addc_u32 s7, s7, 0
    global_load_lds_dwordx4 v10, s[6:7] nt
    s_waitcnt vmcnt(27)
    s_mov_b32 m0, 48128
    s_add_u32 s6, s6, 1024
    s_addc_u32 s7, s7, 0
    global_load_lds_dwordx4 v10, s[6:7] nt
    s_waitcnt vmcnt(27)
    s_mov_b32 m0, 49152
    s_add_u32 s6, s6, 1024
    s_addc_u32 s7, s7, 0
    global_load_lds_dwordx4 v10, s[6:7] nt
    s_waitcnt vmcnt(27)
    s_mov_b32 m0, 50176
    s_add_u32 s6, s6, 1024
    s_addc_u32 s7, s7, 0
    global_load_lds_dwordx4 v10, s[6:7] nt
    s_waitcnt vmcnt(27)
    s_mov_b32 m0, 51200
    s_add_u32 s6, s6, 1024
    s_addc_u32 s7, s7, 0
    global_load_lds_dwordx4 v10, s[6:7] nt
    s_waitcnt vmcnt(27)
    s_mov_b32 m0, 52224
    s_add_u32 s6, s6, 1024
    s_addc_u32 s7, s7, 0
    global_load_lds_dwordx4 v10, s[6:7] nt
    s_waitcnt vmcnt(27)
    s_mov_b32 m0, 53248
    s_add_u32 s6, s6, 1024
    s_addc_u32 s7, s7, 0
    global_load_lds_dwordx4 v10, s[6:7] nt
    s_waitcnt vmcnt(27)
    s_mov_b32 m0, 54272
    s_add_u32 s6, s6, 1024
    s_addc_u32 s7, s7, 0
    global_load_lds_dwordx4 v10, s[6:7] nt
    s_waitcnt vmcnt(27)
    s_mov_b32 m0, 55296
    s_add_u32 s6, s6, 1024
    s_addc_u32 s7, s7, 0
    global_load_lds_dwordx4 v10, s[6:7] nt
    s_waitcnt vmcnt(27)
    s_mov_b32 m0, 56320
    s_add_u32 s6, s6, 1024
    s_addc_u32 s7, s7, 0
    global_load_lds_dwordx4 v10, s[6:7] nt
    s_waitcnt vmcnt(27)
    s_mov_b32 m0, 57344
    s_add_u32 s6, s6, 1024
    s_addc_u32 s7, s7, 0
    global_load_lds_dwordx4 v10, s[6:7] nt
    s_waitcnt vmcnt(27)
    s_mov_b32 m0, 58368
    s_add_u32 s6, s6, 1024
    s_addc_u32 s7, s7, 0
    global_load_lds_dwordx4 v10, s[6:7] nt
    s_waitcnt vmcnt(27)
    s_mov_b32 m0, 59392
    s_add_u32 s6, s6, 1024
    s_addc_u32 s7, s7, 0
    global_load_lds_dwordx4 v10, s[6:7] nt
    s_waitcnt vmcnt(27)
    s_mov_b32 m0, 60416
    s_add_u32 s6, s6, 1024
    s_addc_u32 s7, s7, 0
    global_load_lds_dwordx4 v10, s[6:7] nt
    s_waitcnt vmcnt(27)
    s_mov_b32 m0, 61440
    s_add_u32 s6, s6, 1024
    s_addc_u32 s7, s7, 0
    global_load_lds_dwordx4 v10, s[6:7] nt
    s_waitcnt vmcnt(27)
    s_mov_b32 m0, 62464
    s_add_u32 s6, s6, 1024
    s_addc_u32 s7, s7, 0
    global_load_lds_dwordx4 v10, s[6:7] nt
    s_waitcnt vmcnt(27)
    s_mov_b32 m0, 63488
    s_add_u32 s6, s6, 1024
    s_addc_u32 s7, s7, 0
    global_load_lds_dwordx4 v10, s[6:7] nt
    s_waitcnt vmcnt(27)
    s_mov_b32 m0, 64512
    s_add_u32 s6, s6, 1024
    s_addc_u32 s7, s7, 0
    global_load_lds_dwordx4 v10, s[6:7] nt
    s_waitcnt vmcnt(27)
    s_mov_b32 m0, 65536
    s_nop 0
    global_load_lds_dwordx4 v10, s[8:9] nt
    s_waitcnt vmcnt(27)
    s_mov_b32 m0, 66560
    s_add_u32 s8, s8, 1024
    s_addc_u32 s9, s9, 0
    global_load_lds_dwordx4 v10, s[8:9] nt
    s_waitcnt vmcnt(27)
    s_mov_b32 m0, 67584
    s_add_u32 s8, s8, 1024
    s_addc_u32 s9, s9, 0
    global_load_lds_dwordx4 v10, s[8:9] nt
    s_waitcnt vmcnt(27)
    s_mov_b32 m0, 68608
    s_add_u32 s8, s8, 1024
    s_addc_u32 s9, s9, 0
    global_load_lds_dwordx4 v10, s[8:9] nt
    s_waitcnt vmcnt(27)
    s_mov_b32 m0, 69632
    s_add_u32 s8, s8, 1024
    s_addc_u32 s9, s9, 0
    global_load_lds_dwordx4 v10, s[8:9] nt
    s_waitcnt vmcnt(27)
    s_mov_b32 m0, 70656
    s_add_u32 s8, s8, 1024
    s_addc_u32 s9, s9, 0
    global_load_lds_dwordx4 v10, s[8:9] nt
    s_waitcnt vmcnt(27)
    s_mov_b32 m0, 71680
    s_add_u32 s8, s8, 1024
    s_addc_u32 s9, s9, 0
    global_load_lds_dwordx4 v10, s[8:9] nt
    s_waitcnt vmcnt(27)
    s_mov_b32 m0, 72704
    s_add_u32 s8, s8, 1024
    s_addc_u32 s9, s9, 0
    global_load_lds_dwordx4 v10, s[8:9] nt
    s_waitcnt vmcnt(27)
    s_mov_b32 m0, 73728
    s_add_u32 s8, s8, 1024
    s_addc_u32 s9, s9, 0
    global_load_lds_dwordx4 v10, s[8:9] nt
    s_waitcnt vmcnt(27)
    s_mov_b32 m0, 74752
    s_add_u32 s8, s8, 1024
    s_addc_u32 s9, s9, 0
    global_load_lds_dwordx4 v10, s[8:9] nt
    s_waitcnt vmcnt(27)
    s_mov_b32 m0, 75776
    s_add_u32 s8, s8, 1024
    s_addc_u32 s9, s9, 0
    global_load_lds_dwordx4 v10, s[8:9] nt
    s_waitcnt vmcnt(27)
    s_mov_b32 m0, 76800
    s_add_u32 s8, s8, 1024
    s_addc_u32 s9, s9, 0
    global_load_lds_dwordx4 v10, s[8:9] nt
    s_waitcnt vmcnt(27)
    s_mov_b32 m0, 77824
    s_add_u32 s8, s8, 1024
    s_addc_u32 s9, s9, 0
    global_load_lds_dwordx4 v10, s[8:9] nt
    s_waitcnt vmcnt(27)
    s_mov_b32 m0, 78848
    s_add_u32 s8, s8, 1024
    s_addc_u32 s9, s9, 0
    global_load_lds_dwordx4 v10, s[8:9] nt
    s_waitcnt vmcnt(27)
    s_mov_b32 m0, 79872
    s_add_u32 s8, s8, 1024
    s_addc_u32 s9, s9, 0
    global_load_lds_dwordx4 v10, s[8:9] nt
    s_waitcnt vmcnt(27)
    s_mov_b32 m0, 80896
    s_add_u32 s8, s8, 1024
    s_addc_u32 s9, s9, 0
    global_load_lds_dwordx4 v10, s[8:9] nt
    s_waitcnt vmcnt(27)
    s_mov_b32 m0, 81920
    s_add_u32 s8, s8, 1024
    s_addc_u32 s9, s9, 0
    global_load_lds_dwordx4 v10, s[8:9] nt
    s_waitcnt vmcnt(27)
    s_mov_b32 m0, 82944
    s_add_u32 s8, s8, 1024
    s_addc_u32 s9, s9, 0
    global_load_lds_dwordx4 v10, s[8:9] nt
    s_waitcnt vmcnt(27)
    s_mov_b32 m0, 83968
    s_add_u32 s8, s8, 1024
    s_addc_u32 s9, s9, 0
    global_load_lds_dwordx4 v10, s[8:9] nt
    s_waitcnt vmcnt(27)
    s_mov_b32 m0, 84992
    s_add_u32 s8, s8, 1024
    s_addc_u32 s9, s9, 0
    global_load_lds_dwordx4 v10, s[8:9] nt
    s_waitcnt vmcnt(27)
    s_mov_b32 m0, 86016
    s_add_u32 s8, s8, 1024
    s_addc_u32 s9, s9, 0
    global_load_lds_dwordx4 v10, s[8:9] nt
    s_waitcnt vmcnt(27)
    s_mov_b32 m0, 87040
    s_add_u32 s8, s8, 1024
    s_addc_u32 s9, s9, 0
    global_load_lds_dwordx4 v10, s[8:9] nt
    s_waitcnt vmcnt(27)
    s_mov_b32 m0, 88064
    s_add_u32 s8, s8, 1024
    s_addc_u32 s9, s9, 0
    global_load_lds_dwordx4 v10, s[8:9] nt
    s_waitcnt vmcnt(27)
    s_mov_b32 m0, 89088
    s_add_u32 s8, s8, 1024
    s_addc_u32 s9, s9, 0
    global_load_lds_dwordx4 v10, s[8:9] nt
    s_waitcnt vmcnt(27)
    s_mov_b32 m0, 90112
    s_add_u32 s8, s8, 1024
    s_addc_u32 s9, s9, 0
    global_load_lds_dwordx4 v10, s[8:9] nt
    s_waitcnt vmcnt(27)
    s_mov_b32 m0, 91136
    s_add_u32 s8, s8, 1024
    s_addc_u32 s9, s9, 0
    global_load_lds_dwordx4 v10, s[8:9] nt
    s_waitcnt vmcnt(27)
    s_mov_b32 m0, 92160
    s_add_u32 s8, s8, 1024
    s_addc_u32 s9, s9, 0
    global_load_lds_dwordx4 v10, s[8:9] nt
    s_waitcnt vmcnt(27)
    ds_write_b32 v253, v225 offset:68
    s_mov_b32 m0, 93184
    s_add_u32 s8, s8, 1024
    s_addc_u32 s9, s9, 0
    global_load_lds_dwordx4 v10, s[8:9] nt
    s_waitcnt vmcnt(27)
    s_mov_b32 m0, 94208
    s_add_u32 s8, s8, 1024
    s_addc_u32 s9, s9, 0
    global_load_lds_dwordx4 v10, s[8:9] nt
    s_waitcnt vmcnt(27)
    s_mov_b32 m0, 95232
    s_add_u32 s8, s8, 1024
    s_addc_u32 s9, s9, 0
    global_load_lds_dwordx4 v10, s[8:9] nt
    s_waitcnt vmcnt(27)
    s_mov_b32 m0, 96256
    s_add_u32 s8, s8, 1024
    s_addc_u32 s9, s9, 0
    global_load_lds_dwordx4 v10, s[8:9] nt
    s_waitcnt vmcnt(27)
    s_mov_b32 m0, 97280
    s_add_u32 s8, s8, 1024
    s_addc_u32 s9, s9, 0
    global_load_lds_dwordx4 v10, s[8:9] nt
    s_waitcnt vmcnt(27)
    s_mov_b32 m0, 98304
    s_nop 0
    global_load_lds_dwordx4 v11, s[12:13] nt
    s_waitcnt vmcnt(27)
    s_mov_b32 m0, 99328
    s_add_u32 s12, s12, 8192
    s_addc_u32 s13, s13, 0
    global_load_lds_dwordx4 v11, s[12:13] nt
    s_waitcnt vmcnt(27)
    s_mov_b32 m0, 100352
    s_add_u32 s12, s12, 8192
    s_addc_u32 s13, s13, 0
    global_load_lds_dwordx4 v11, s[12:13] nt
    s_waitcnt vmcnt(27)
    s_mov_b32 m0, 101376
    s_add_u32 s12, s12, 8192
    s_addc_u32 s13, s13, 0
    global_load_lds_dwordx4 v11, s[12:13] nt
    s_waitcnt vmcnt(27)
    s_mov_b32 m0, 102400
    s_add_u32 s12, s12, 8192
    s_addc_u32 s13, s13, 0
    global_load_lds_dwordx4 v11, s[12:13] nt
    s_waitcnt vmcnt(27)
    s_mov_b32 m0, 103424
    s_add_u32 s12, s12, 8192
    s_addc_u32 s13, s13, 0
    global_load_lds_dwordx4 v11, s[12:13] nt
    s_waitcnt vmcnt(27)
    s_mov_b32 m0, 104448
    s_add_u32 s12, s12, 8192
    s_addc_u32 s13, s13, 0
    global_load_lds_dwordx4 v11, s[12:13] nt
    s_waitcnt vmcnt(27)
    s_mov_b32 m0, 105472
    s_add_u32 s12, s12, 8192
    s_addc_u32 s13, s13, 0
    global_load_lds_dwordx4 v11, s[12:13] nt
    s_waitcnt vmcnt(27)
    s_mov_b32 m0, 106496
    s_add_u32 s12, s12, 8192
    s_addc_u32 s13, s13, 0
    global_load_lds_dwordx4 v11, s[12:13] nt
    s_waitcnt vmcnt(27)
    s_mov_b32 m0, 107520
    s_add_u32 s12, s12, 8192
    s_addc_u32 s13, s13, 0
    global_load_lds_dwordx4 v11, s[12:13] nt
    s_waitcnt vmcnt(27)
    s_mov_b32 m0, 108544
    s_add_u32 s12, s12, 8192
    s_addc_u32 s13, s13, 0
    global_load_lds_dwordx4 v11, s[12:13] nt
    s_waitcnt vmcnt(27)
    s_mov_b32 m0, 109568
    s_add_u32 s12, s12, 8192
    s_addc_u32 s13, s13, 0
    global_load_lds_dwordx4 v11, s[12:13] nt
    s_waitcnt vmcnt(27)
    s_mov_b32 m0, 110592
    s_add_u32 s12, s12, 8192
    s_addc_u32 s13, s13, 0
    global_load_lds_dwordx4 v11, s[12:13] nt
    s_waitcnt vmcnt(27)
    s_mov_b32 m0, 111616
    s_add_u32 s12, s12, 8192
    s_addc_u32 s13, s13, 0
    global_load_lds_dwordx4 v11, s[12:13] nt
    s_waitcnt vmcnt(27)
    s_mov_b32 m0, 112640
    s_add_u32 s12, s12, 8192
    s_addc_u32 s13, s13, 0
    global_load_lds_dwordx4 v11, s[12:13] nt
    s_waitcnt vmcnt(27)
    s_mov_b32 m0, 113664
    s_add_u32 s12, s12, 8192
    s_addc_u32 s13, s13, 0
    global_load_lds_dwordx4 v11, s[12:13] nt
    s_waitcnt vmcnt(27)
    s_mov_b32 m0, 114688
    s_add_u32 s12, s12, 8192
    s_addc_u32 s13, s13, 0
    global_load_lds_dwordx4 v11, s[12:13] nt
    s_waitcnt vmcnt(27)
    s_mov_b32 m0, 115712
    s_add_u32 s12, s12, 8192
    s_addc_u32 s13, s13, 0
    global_load_lds_dwordx4 v11, s[12:13] nt
    s_waitcnt vmcnt(27)
    s_mov_b32 m0, 116736
    s_add_u32 s12, s12, 8192
    s_addc_u32 s13, s13, 0
    global_load_lds_dwordx4 v11, s[12:13] nt
    s_waitcnt vmcnt(27)
    s_mov_b32 m0, 117760
    s_add_u32 s12, s12, 8192
    s_addc_u32 s13, s13, 0
    global_load_lds_dwordx4 v11, s[12:13] nt
    s_waitcnt vmcnt(27)
    s_mov_b32 m0, 118784
    s_add_u32 s12, s12, 8192
    s_addc_u32 s13, s13, 0
    global_load_lds_dwordx4 v11, s[12:13] nt
    s_waitcnt vmcnt(27)
    s_mov_b32 m0, 119808
    s_add_u32 s12, s12, 8192
    s_addc_u32 s13, s13, 0
    global_load_lds_dwordx4 v11, s[12:13] nt
    s_waitcnt vmcnt(27)
    s_mov_b32 m0, 120832
    s_add_u32 s12, s12, 8192
    s_addc_u32 s13, s13, 0
    global_load_lds_dwordx4 v11, s[12:13] nt
    s_waitcnt vmcnt(27)
    s_mov_b32 m0, 121856
    s_add_u32 s12, s12, 8192
    s_addc_u32 s13, s13, 0
    global_load_lds_dwordx4 v11, s[12:13] nt
    s_waitcnt vmcnt(27)
    s_mov_b32 m0, 122880
    s_add_u32 s12, s12, 8192
    s_addc_u32 s13, s13, 0
    global_load_lds_dwordx4 v11, s[12:13] nt
    s_waitcnt vmcnt(27)
    s_mov_b32 m0, 123904
    s_add_u32 s12, s12, 8192
    s_addc_u32 s13, s13, 0
    global_load_lds_dwordx4 v11, s[12:13] nt
    s_waitcnt vmcnt(27)
    s_mov_b32 m0, 124928
    s_add_u32 s12, s12, 8192
    s_addc_u32 s13, s13, 0
    global_load_lds_dwordx4 v11, s[12:13] nt
    s_waitcnt vmcnt(27)
    ds_write_b32 v253, v225 offset:72
    s_mov_b32 m0, 125952
    s_add_u32 s12, s12, 8192
    s_addc_u32 s13, s13, 0
    global_load_lds_dwordx4 v11, s[12:13] nt
    s_waitcnt vmcnt(27)
    s_mov_b32 m0, 126976
    s_add_u32 s12, s12, 8192
    s_addc_u32 s13, s13, 0
    global_load_lds_dwordx4 v11, s[12:13] nt
    s_waitcnt vmcnt(27)
    s_mov_b32 m0, 128000
    s_add_u32 s12, s12, 8192
    s_addc_u32 s13, s13, 0
    global_load_lds_dwordx4 v11, s[12:13] nt
    s_waitcnt vmcnt(27)
    s_mov_b32 m0, 129024
    s_add_u32 s12, s12, 8192
    s_addc_u32 s13, s13, 0
    global_load_lds_dwordx4 v11, s[12:13] nt
    s_waitcnt vmcnt(27)
    s_mov_b32 m0, 130048
    s_add_u32 s12, s12, 8192
    s_addc_u32 s13, s13, 0
    global_load_lds_dwordx4 v11, s[12:13] nt
    s_cmp_ge_u32 s32, 28
    s_cbranch_scc1 L_ldshort2
lw_176:
    ds_read_b32 v4, v253 offset:20
    s_waitcnt lgkmcnt(0)
    v_cmp_gt_u32 vcc, 4, v4
    s_cbranch_vccnz rt_177
    s_waitcnt vmcnt(27)
    s_mov_b32 m0, 0
    s_nop 0
    global_load_lds_dwordx4 v12, s[16:17] nt
    s_waitcnt vmcnt(27)
    s_mov_b32 m0, 1024
    s_add_u32 s16, s16, 28672
    s_addc_u32 s17, s17, 0
    global_load_lds_dwordx4 v12, s[16:17] nt
    s_waitcnt vmcnt(27)
    s_mov_b32 m0, 2048
    s_add_u32 s16, s16, 28672
    s_addc_u32 s17, s17, 0
    global_load_lds_dwordx4 v12, s[16:17] nt
    s_waitcnt vmcnt(27)
    s_mov_b32 m0, 3072
    s_add_u32 s16, s16, 28672
    s_addc_u32 s17, s17, 0
    global_load_lds_dwordx4 v12, s[16:17] nt
    s_waitcnt vmcnt(27)
    s_mov_b32 m0, 4096
    s_add_u32 s16, s16, 28672
    s_addc_u32 s17, s17, 0
    global_load_lds_dwordx4 v12, s[16:17] nt
    s_waitcnt vmcnt(27)
    s_mov_b32 m0, 5120
    s_add_u32 s16, s16, 28672
    s_addc_u32 s17, s17, 0
    global_load_lds_dwordx4 v12, s[16:17] nt
    s_waitcnt vmcnt(27)
    s_mov_b32 m0, 6144
    s_add_u32 s16, s16, 28672
    s_addc_u32 s17, s17, 0
    global_load_lds_dwordx4 v12, s[16:17] nt
    s_waitcnt vmcnt(27)
    s_mov_b32 m0, 7168
    s_add_u32 s16, s16, 28672
    s_addc_u32 s17, s17, 0
    global_load_lds_dwordx4 v12, s[16:17] nt
    s_waitcnt vmcnt(27)
    s_mov_b32 m0, 8192
    s_add_u32 s16, s16, 28672
    s_addc_u32 s17, s17, 0
    global_load_lds_dwordx4 v12, s[16:17] nt
    s_waitcnt vmcnt(27)
    s_mov_b32 m0, 9216
    s_add_u32 s16, s16, 28672
    s_addc_u32 s17, s17, 0
    global_load_lds_dwordx4 v12, s[16:17] nt
    s_waitcnt vmcnt(27)
    s_mov_b32 m0, 10240
    s_add_u32 s16, s16, 28672
    s_addc_u32 s17, s17, 0
    global_load_lds_dwordx4 v12, s[16:17] nt
    s_waitcnt vmcnt(27)
    s_mov_b32 m0, 11264
    s_add_u32 s16, s16, 28672
    s_addc_u32 s17, s17, 0
    global_load_lds_dwordx4 v12, s[16:17] nt
    s_waitcnt vmcnt(27)
    s_mov_b32 m0, 12288
    s_add_u32 s16, s16, 28672
    s_addc_u32 s17, s17, 0
    global_load_lds_dwordx4 v12, s[16:17] nt
    s_waitcnt vmcnt(27)
    s_mov_b32 m0, 13312
    s_add_u32 s16, s16, 28672
    s_addc_u32 s17, s17, 0
    global_load_lds_dwordx4 v12, s[16:17] nt
    s_waitcnt vmcnt(27)
    s_mov_b32 m0, 14336
    s_add_u32 s16, s16, 28672
    s_addc_u32 s17, s17, 0
    global_load_lds_dwordx4 v12, s[16:17] nt
    s_waitcnt vmcnt(27)
    s_mov_b32 m0, 15360
    s_add_u32 s16, s16, 28672
    s_addc_u32 s17, s17, 0
    global_load_lds_dwordx4 v12, s[16:17] nt
    s_waitcnt vmcnt(27)
    s_mov_b32 m0, 16384
    s_add_u32 s16, s16, 28672
    s_addc_u32 s17, s17, 0
    global_load_lds_dwordx4 v12, s[16:17] nt
    s_waitcnt vmcnt(27)
    s_mov_b32 m0, 17408
    s_add_u32 s16, s16, 28672
    s_addc_u32 s17, s17, 0
    global_load_lds_dwordx4 v12, s[16:17] nt
    s_waitcnt vmcnt(27)
    s_mov_b32 m0, 18432
    s_add_u32 s16, s16, 28672
    s_addc_u32 s17, s17, 0
    global_load_lds_dwordx4 v12, s[16:17] nt
    s_waitcnt vmcnt(27)
    s_mov_b32 m0, 19456
    s_add_u32 s16, s16, 28672
    s_addc_u32 s17, s17, 0
    global_load_lds_dwordx4 v12, s[16:17] nt
    s_waitcnt vmcnt(27)
    s_mov_b32 m0, 20480
    s_add_u32 s16, s16, 28672
    s_addc_u32 s17, s17, 0
    global_load_lds_dwordx4 v12, s[16:17] nt
    s_waitcnt vmcnt(27)
    s_mov_b32 m0, 21504
    s_add_u32 s16, s16, 28672
    s_addc_u32 s17, s17, 0
    global_load_lds_dwordx4 v12, s[16:17] nt
    s_waitcnt vmcnt(27)
    s_mov_b32 m0, 22528
    s_add_u32 s16, s16, 28672
    s_addc_u32 s17, s17, 0
    global_load_lds_dwordx4 v12, s[16:17] nt
    s_waitcnt vmcnt(27)
    s_mov_b32 m0, 23552
    s_add_u32 s16, s16, 28672
    s_addc_u32 s17, s17, 0
    global_load_lds_dwordx4 v12, s[16:17] nt
    s_waitcnt vmcnt(27)
    s_mov_b32 m0, 24576
    s_add_u32 s16, s16, 28672
    s_addc_u32 s17, s17, 0
    global_load_lds_dwordx4 v12, s[16:17] nt
    s_waitcnt vmcnt(27)
    s_mov_b32 m0, 25600
    s_add_u32 s16, s16, 28672
    s_addc_u32 s17, s17, 0
    global_load_lds_dwordx4 v12, s[16:17] nt
    s_waitcnt vmcnt(27)
    s_mov_b32 m0, 26624
    s_add_u32 s16, s16, 28672
    s_addc_u32 s17, s17, 0
    global_load_lds_dwordx4 v12, s[16:17] nt
    s_waitcnt vmcnt(27)
    ds_write_b32 v253, v225 offset:76
    s_mov_b32 m0, 27648
    s_add_u32 s16, s16, 28672
    s_addc_u32 s17, s17, 0
    global_load_lds_dwordx4 v12, s[16:17] nt
    s_waitcnt vmcnt(27)
    s_mov_b32 m0, 28672
    s_add_u32 s16, s16, 28672
    s_addc_u32 s17, s17, 0
    global_load_lds_dwordx4 v12, s[16:17] nt
    s_waitcnt vmcnt(27)
    s_mov_b32 m0, 29696
    s_add_u32 s16, s16, 28672
    s_addc_u32 s17, s17, 0
    global_load_lds_dwordx4 v12, s[16:17] nt
    s_waitcnt vmcnt(27)
    s_mov_b32 m0, 30720
    s_add_u32 s16, s16, 28672
    s_addc_u32 s17, s17, 0
    global_load_lds_dwordx4 v12, s[16:17] nt
    s_waitcnt vmcnt(27)
    s_mov_b32 m0, 31744
    s_add_u32 s16, s16, 28672
    s_addc_u32 s17, s17, 0
    global_load_lds_dwordx4 v12, s[16:17] nt
lw_178:
    ds_read_b32 v4, v253 offset:60
    s_waitcnt lgkmcnt(0)
    v_cmp_gt_u32 vcc, 4, v4
    s_cbranch_vccnz rt_179
    s_waitcnt vmcnt(27)
    s_mov_b32 m0, 32768
    s_nop 0
    global_load_lds_dwordx4 v11, s[20:21] nt
    s_waitcnt vmcnt(27)
    s_mov_b32 m0, 33792
    s_add_u32 s20, s20, 8192
    s_addc_u32 s21, s21, 0
    global_load_lds_dwordx4 v11, s[20:21] nt
    s_waitcnt vmcnt(27)
    s_mov_b32 m0, 34816
    s_add_u32 s20, s20, 8192
    s_addc_u32 s21, s21, 0
    global_load_lds_dwordx4 v11, s[20:21] nt
    s_waitcnt vmcnt(27)
    s_mov_b32 m0, 35840
    s_add_u32 s20, s20, 8192
    s_addc_u32 s21, s21, 0
    global_load_lds_dwordx4 v11, s[20:21] nt
    s_waitcnt vmcnt(27)
    s_mov_b32 m0, 36864
    s_add_u32 s20, s20, 8192
    s_addc_u32 s21, s21, 0
    global_load_lds_dwordx4 v11, s[20:21] nt
    s_waitcnt vmcnt(27)
    s_mov_b32 m0, 37888
    s_add_u32 s20, s20, 8192
    s_addc_u32 s21, s21, 0
    global_load_lds_dwordx4 v11, s[20:21] nt
    s_waitcnt vmcnt(27)
    s_mov_b32 m0, 38912
    s_add_u32 s20, s20, 8192
    s_addc_u32 s21, s21, 0
    global_load_lds_dwordx4 v11, s[20:21] nt
    s_waitcnt vmcnt(27)
    s_mov_b32 m0, 39936
    s_add_u32 s20, s20, 8192
    s_addc_u32 s21, s21, 0
    global_load_lds_dwordx4 v11, s[20:21] nt
    s_waitcnt vmcnt(27)
    s_mov_b32 m0, 40960
    s_add_u32 s20, s20, 8192
    s_addc_u32 s21, s21, 0
    global_load_lds_dwordx4 v11, s[20:21] nt
    s_waitcnt vmcnt(27)
    s_mov_b32 m0, 41984
    s_add_u32 s20, s20, 8192
    s_addc_u32 s21, s21, 0
    global_load_lds_dwordx4 v11, s[20:21] nt
    s_waitcnt vmcnt(27)
    s_mov_b32 m0, 43008
    s_add_u32 s20, s20, 8192
    s_addc_u32 s21, s21, 0
    global_load_lds_dwordx4 v11, s[20:21] nt
    s_waitcnt vmcnt(27)
    s_mov_b32 m0, 44032
    s_add_u32 s20, s20, 8192
    s_addc_u32 s21, s21, 0
    global_load_lds_dwordx4 v11, s[20:21] nt
    s_waitcnt vmcnt(27)
    s_mov_b32 m0, 45056
    s_add_u32 s20, s20, 8192
    s_addc_u32 s21, s21, 0
    global_load_lds_dwordx4 v11, s[20:21] nt
    s_waitcnt vmcnt(27)
    s_mov_b32 m0, 46080
    s_add_u32 s20, s20, 8192
    s_addc_u32 s21, s21, 0
    global_load_lds_dwordx4 v11, s[20:21] nt
    s_waitcnt vmcnt(27)
    s_mov_b32 m0, 47104
    s_add_u32 s20, s20, 8192
    s_addc_u32 s21, s21, 0
    global_load_lds_dwordx4 v11, s[20:21] nt
    s_waitcnt vmcnt(27)
    s_mov_b32 m0, 48128
    s_add_u32 s20, s20, 8192
    s_addc_u32 s21, s21, 0
    global_load_lds_dwordx4 v11, s[20:21] nt
    s_waitcnt vmcnt(27)
    s_mov_b32 m0, 49152
    s_add_u32 s20, s20, 8192
    s_addc_u32 s21, s21, 0
    global_load_lds_dwordx4 v11, s[20:21] nt
    s_waitcnt vmcnt(27)
    s_mov_b32 m0, 50176
    s_add_u32 s20, s20, 8192
    s_addc_u32 s21, s21, 0
    global_load_lds_dwordx4 v11, s[20:21] nt
    s_waitcnt vmcnt(27)
    s_mov_b32 m0, 51200
    s_add_u32 s20, s20, 8192
    s_addc_u32 s21, s21, 0
    global_load_lds_dwordx4 v11, s[20:21] nt
    s_waitcnt vmcnt(27)
    s_mov_b32 m0, 52224
    s_add_u32 s20, s20, 8192
    s_addc_u32 s21, s21, 0
    global_load_lds_dwordx4 v11, s[20:21] nt
    s_waitcnt vmcnt(27)
    s_mov_b32 m0, 53248
    s_add_u32 s20, s20, 8192
    s_addc_u32 s21, s21, 0
    global_load_lds_dwordx4 v11, s[20:21] nt
    s_waitcnt vmcnt(27)
    s_mov_b32 m0, 54272
    s_add_u32 s20, s20, 8192
    s_addc_u32 s21, s21, 0
    global_load_lds_dwordx4 v11, s[20:21] nt
    s_waitcnt vmcnt(27)
    s_mov_b32 m0, 55296
    s_add_u32 s20, s20, 8192
    s_addc_u32 s21, s21, 0
    global_load_lds_dwordx4 v11, s[20:21] nt
    s_waitcnt vmcnt(27)
    s_mov_b32 m0, 56320
    s_add_u32 s20, s20, 8192
    s_addc_u32 s21, s21, 0
    global_load_lds_dwordx4 v11, s[20:21] nt
    s_waitcnt vmcnt(27)
    s_mov_b32 m0, 57344
    s_add_u32 s20, s20, 8192
    s_addc_u32 s21, s21, 0
    global_load_lds_dwordx4 v11, s[20:21] nt
    s_waitcnt vmcnt(27)
    s_mov_b32 m0, 58368
    s_add_u32 s20, s20, 8192
    s_addc_u32 s21, s21, 0
    global_load_lds_dwordx4 v11, s[20:21] nt
    s_waitcnt vmcnt(27)
    s_mov_b32 m0, 59392
    s_add_u32 s20, s20, 8192
    s_addc_u32 s21, s21, 0
    global_load_lds_dwordx4 v11, s[20:21] nt
    s_waitcnt vmcnt(27)
    ds_write_b32 v253, v225 offset:80
    s_mov_b32 m0, 60416
    s_add_u32 s20, s20, 8192
    s_addc_u32 s21, s21, 0
    global_load_lds_dwordx4 v11, s[20:21] nt
    s_waitcnt vmcnt(27)
    s_mov_b32 m0, 61440
    s_add_u32 s20, s20, 8192
    s_addc_u32 s21, s21, 0
    global_load_lds_dwordx4 v11, s[20:21] nt
    s_waitcnt vmcnt(27)
    s_mov_b32 m0, 62464
    s_add_u32 s20, s20, 8192
    s_addc_u32 s21, s21, 0
    global_load_lds_dwordx4 v11, s[20:21] nt
    s_waitcnt vmcnt(27)
    s_mov_b32 m0, 63488
    s_add_u32 s20, s20, 8192
    s_addc_u32 s21, s21, 0
    global_load_lds_dwordx4 v11, s[20:21] nt
    s_waitcnt vmcnt(27)
    s_mov_b32 m0, 64512
    s_add_u32 s20, s20, 8192
    s_addc_u32 s21, s21, 0
    global_load_lds_dwordx4 v11, s[20:21] nt
    s_waitcnt vmcnt(32)
    ds_write_b32 v253, v225 offset:80
    s_waitcnt vmcnt(0)
    ds_write_b32 v253, v225 offset:84
    s_waitcnt lgkmcnt(0)
    s_endpgm
L_ldshort2:
    s_waitcnt vmcnt(32)
    ds_write_b32 v253, v225 offset:72
    s_branch L_ldshort
    ds_read_b32 v4, v253 offset:56
    s_waitcnt lgkmcnt(0)
    v_cmp_le_u32 vcc, 4, v4
    s_cbranch_vccnz sw_180
    s_waitcnt vmcnt(9)
    s_mov_b32 m0, 32768
    global_load_lds_dwordx4 v10, s[6:7] nt
    s_waitcnt vmcnt(9)
    s_mov_b32 m0, 33792
    s_add_u32 s6, s6, 1024
    s_addc_u32 s7, s7, 0
    global_load_lds_dwordx4 v10, s[6:7] nt
    ds_read_b32 v4, v253 offset:56
    s_waitcnt lgkmcnt(0)
    v_cmp_le_u32 vcc, 4, v4
    s_cbranch_vccnz sw_182
    s_waitcnt vmcnt(9)
    s_mov_b32 m0, 34816
    s_add_u32 s6, s6, 1024
    s_addc_u32 s7, s7, 0
    global_load_lds_dwordx4 v10, s[6:7] nt
    s_waitcnt vmcnt(9)
    s_mov_b32 m0, 35840
    s_add_u32 s6, s6, 1024
    s_addc_u32 s7, s7, 0
    global_load_lds_dwordx4 v10, s[6:7] nt
    ds_read_b32 v4, v253 offset:56
    s_waitcnt lgkmcnt(0)
    v_cmp_le_u32 vcc, 4, v4
    s_cbranch_vccnz sw_184
    s_waitcnt vmcnt(9)
    s_mov_b32 m0, 36864
    s_add_u32 s6, s6, 1024
    s_addc_u32 s7, s7, 0
    global_load_lds_dwordx4 v10, s[6:7] nt
    s_waitcnt vmcnt(9)
    s_mov_b32 m0, 37888
    s_add_u32 s6, s6, 1024
    s_addc_u32 s7, s7, 0
    global_load_lds_dwordx4 v10, s[6:7] nt
    ds_read_b32 v4, v253 offset:56
    s_waitcnt lgkmcnt(0)
    v_cmp_le_u32 vcc, 4, v4
    s_cbranch_vccnz sw_186
    s_waitcnt vmcnt(9)
    s_mov_b32 m0, 38912
    s_add_u32 s6, s6, 1024
    s_addc_u32 s7, s7, 0
    global_load_lds_dwordx4 v10, s[6:7] nt
    s_waitcnt vmcnt(9)
    s_mov_b32 m0, 39936
    s_add_u32 s6, s6, 1024
    s_addc_u32 s7, s7, 0
    global_load_lds_dwordx4 v10, s[6:7] nt
    ds_read_b32 v4, v253 offset:56
    s_waitcnt lgkmcnt(0)
    v_cmp_le_u32 vcc, 4, v4
    s_cbranch_vccnz sw_188
    s_waitcnt vmcnt(9)
    s_mov_b32 m0, 40960
    s_add_u32 s6, s6, 1024
    s_addc_u32 s7, s7, 0
    global_load_lds_dwordx4 v10, s[6:7] nt
    s_waitcnt vmcnt(9)
    ds_write_b32 v253, v225 offset:64
    s_mov_b32 m0, 41984
    s_add_u32 s6, s6, 1024
    s_addc_u32 s7, s7, 0
    global_load_lds_dwordx4 v10, s[6:7] nt
    ds_read_b32 v4, v253 offset:56
    s_waitcnt lgkmcnt(0)
    v_cmp_le_u32 vcc, 4, v4
    s_cbranch_vccnz sw_190
    s_waitcnt vmcnt(9)
    s_mov_b32 m0, 43008
    s_add_u32 s6, s6, 1024
    s_addc_u32 s7, s7, 0
    global_load_lds_dwordx4 v10, s[6:7] nt
    s_waitcnt vmcnt(9)
    s_mov_b32 m0, 44032
    s_add_u32 s6, s6, 1024
    s_addc_u32 s7, s7, 0
    global_load_lds_dwordx4 v10, s[6:7] nt
    ds_read_b32 v4, v253 offset:56
    s_waitcnt lgkmcnt(0)
    v_cmp_le_u32 vcc, 4, v4
    s_cbranch_vccnz sw_192
    s_waitcnt vmcnt(9)
    s_mov_b32 m0, 45056
    s_add_u32 s6, s6, 1024
    s_addc_u32 s7, s7, 0
    global_load_lds_dwordx4 v10, s[6:7] nt
    s_waitcnt vmcnt(9)
    s_mov_b32 m0, 46080
    s_add_u32 s6, s6, 1024
    s_addc_u32 s7, s7, 0
    global_load_lds_dwordx4 v10, s[6:7] nt
    ds_read_b32 v4, v253 offset:56
    s_waitcnt lgkmcnt(0)
    v_cmp_le_u32 vcc, 4, v4
    s_cbranch_vccnz sw_194
    s_waitcnt vmcnt(9)
    s_mov_b32 m0, 47104
    s_add_u32 s6, s6, 1024
    s_addc_u32 s7, s7, 0
    global_load_lds_dwordx4 v10, s[6:7] nt
    s_waitcnt vmcnt(9)
    s_mov_b32 m0, 48128
    s_add_u32 s6, s6, 1024
    s_addc_u32 s7, s7, 0
    global_load_lds_dwordx4 v10, s[6:7] nt
    ds_read_b32 v4, v253 offset:56
    s_waitcnt lgkmcnt(0)
    v_cmp_le_u32 vcc, 4, v4
    s_cbranch_vccnz sw_196
    s_waitcnt vmcnt(9)
    s_mov_b32 m0, 49152
    s_add_u32 s6, s6, 1024
    s_addc_u32 s7, s7, 0
    global_load_lds_dwordx4 v10, s[6:7] nt
    s_waitcnt vmcnt(9)
    s_mov_b32 m0, 50176
    s_add_u32 s6, s6, 1024
    s_addc_u32 s7, s7, 0
    global_load_lds_dwordx4 v10, s[6:7] nt
    ds_read_b32 v4, v253 offset:56
    s_waitcnt lgkmcnt(0)
    v_cmp_le_u32 vcc, 4, v4
    s_cbranch_vccnz sw_198
    s_waitcnt vmcnt(9)
    s_mov_b32 m0, 51200
    s_add_u32 s6, s6, 1024
    s_addc_u32 s7, s7, 0
    global_load_lds_dwordx4 v10, s[6:7] nt
    s_waitcnt vmcnt(9)
    s_mov_b32 m0, 52224
    s_add_u32 s6, s6, 1024
    s_addc_u32 s7, s7, 0
    global_load_lds_dwordx4 v10, s[6:7] nt
    ds_read_b32 v4, v253 offset:56
    s_waitcnt lgkmcnt(0)
    v_cmp_le_u32 vcc, 4, v4
    s_cbranch_vccnz sw_200
    s_waitcnt vmcnt(9)
    s_mov_b32 m0, 53248
    s_add_u32 s6, s6, 1024
    s_addc_u32 s7, s7, 0
    global_load_lds_dwordx4 v10, s[6:7] nt
    s_waitcnt vmcnt(9)
    s_mov_b32 m0, 54272
    s_add_u32 s6, s6, 1024
    s_addc_u32 s7, s7, 0
    global_load_lds_dwordx4 v10, s[6:7] nt
    ds_read_b32 v4, v253 offset:56
    s_waitcnt lgkmcnt(0)
    v_cmp_le_u32 vcc, 4, v4
    s_cbranch_vccnz sw_202
    s_waitcnt vmcnt(9)
    s_mov_b32 m0, 55296
    s_add_u32 s6, s6, 1024
    s_addc_u32 s7, s7, 0
    global_load_lds_dwordx4 v10, s[6:7] nt
    s_waitcnt vmcnt(9)
    s_mov_b32 m0, 56320
    s_add_u32 s6, s6, 1024
    s_addc_u32 s7, s7, 0
    global_load_lds_dwordx4 v10, s[6:7] nt
    ds_read_b32 v4, v253 offset:56
    s_waitcnt lgkmcnt(0)
    v_cmp_le_u32 vcc, 4, v4
    s_cbranch_vccnz sw_204
    s_waitcnt vmcnt(9)
    s_mov_b32 m0, 57344
    s_add_u32 s6, s6, 1024
    s_addc_u32 s7, s7, 0
    global_load_lds_dwordx4 v10, s[6:7] nt
    s_waitcnt vmcnt(9)
    s_mov_b32 m0, 58368
    s_add_u32 s6, s6, 1024
    s_addc_u32 s7, s7, 0
    global_load_lds_dwordx4 v10, s[6:7] nt
    ds_read_b32 v4, v253 offset:56
    s_waitcnt lgkmcnt(0)
    v_cmp_le_u32 vcc, 4, v4
    s_cbranch_vccnz sw_206
    s_waitcnt vmcnt(9)
    s_mov_b32 m0, 59392
    s_add_u32 s6, s6, 1024
    s_addc_u32 s7, s7, 0
    global_load_lds_dwordx4 v10, s[6:7] nt
    s_waitcnt vmcnt(9)
    s_mov_b32 m0, 60416
    s_add_u32 s6, s6, 1024
    s_addc_u32 s7, s7, 0
    global_load_lds_dwordx4 v10, s[6:7] nt
    ds_read_b32 v4, v253 offset:56
    s_waitcnt lgkmcnt(0)
    v_cmp_le_u32 vcc, 4, v4
    s_cbranch_vccnz sw_208
    s_waitcnt vmcnt(9)
    s_mov_b32 m0, 61440
    s_add_u32 s6, s6, 1024
    s_addc_u32 s7, s7, 0
    global_load_lds_dwordx4 v10, s[6:7] nt
    s_waitcnt vmcnt(9)
    s_mov_b32 m0, 62464
    s_add_u32 s6, s6, 1024
    s_addc_u32 s7, s7, 0
    global_load_lds_dwordx4 v10, s[6:7] nt
    ds_read_b32 v4, v253 offset:56
    s_waitcnt lgkmcnt(0)
    v_cmp_le_u32 vcc, 4, v4
    s_cbranch_vccnz sw_210
    s_waitcnt vmcnt(9)
    s_mov_b32 m0, 63488
    s_add_u32 s6, s6, 1024
    s_addc_u32 s7, s7, 0
    global_load_lds_dwordx4 v10, s[6:7] nt
    s_waitcnt vmcnt(9)
    s_mov_b32 m0, 64512
    s_add_u32 s6, s6, 1024
    s_addc_u32 s7, s7, 0
    global_load_lds_dwordx4 v10, s[6:7] nt
    ds_read_b32 v4, v253 offset:56
    s_waitcnt lgkmcnt(0)
    v_cmp_le_u32 vcc, 4, v4
    s_cbranch_vccnz sw_212
    s_waitcnt vmcnt(9)
    s_mov_b32 m0, 65536
    global_load_lds_dwordx4 v10, s[8:9] nt
    s_waitcnt vmcnt(9)
    s_mov_b32 m0, 66560
    s_add_u32 s8, s8, 1024
    s_addc_u32 s9, s9, 0
    global_load_lds_dwordx4 v10, s[8:9] nt
    ds_read_b32 v4, v253 offset:56
    s_waitcnt lgkmcnt(0)
    v_cmp_le_u32 vcc, 4, v4
    s_cbranch_vccnz sw_214
    s_waitcnt vmcnt(9)
    s_mov_b32 m0, 67584
    s_add_u32 s8, s8, 1024
    s_addc_u32 s9, s9, 0
    global_load_lds_dwordx4 v10, s[8:9] nt
    s_waitcnt vmcnt(9)
    s_mov_b32 m0, 68608
    s_add_u32 s8, s8, 1024
    s_addc_u32 s9, s9, 0
    global_load_lds_dwordx4 v10, s[8:9] nt
    ds_read_b32 v4, v253 offset:56
    s_waitcnt lgkmcnt(0)
    v_cmp_le_u32 vcc, 4, v4
    s_cbranch_vccnz sw_216
    s_waitcnt vmcnt(9)
    s_mov_b32 m0, 69632
    s_add_u32 s8, s8, 1024
    s_addc_u32 s9, s9, 0
    global_load_lds_dwordx4 v10, s[8:9] nt
    s_waitcnt vmcnt(9)
    s_mov_b32 m0, 70656
    s_add_u32 s8, s8, 1024
    s_addc_u32 s9, s9, 0
    global_load_lds_dwordx4 v10, s[8:9] nt
    ds_read_b32 v4, v253 offset:56
    s_waitcnt lgkmcnt(0)
    v_cmp_le_u32 vcc, 4, v4
    s_cbranch_vccnz sw_218
    s_waitcnt vmcnt(9)
    s_mov_b32 m0, 71680
    s_add_u32 s8, s8, 1024
    s_addc_u32 s9, s9, 0
    global_load_lds_dwordx4 v10, s[8:9] nt
    s_waitcnt vmcnt(9)
    s_mov_b32 m0, 72704
    s_add_u32 s8, s8, 1024
    s_addc_u32 s9, s9, 0
    global_load_lds_dwordx4 v10, s[8:9] nt
    ds_read_b32 v4, v253 offset:56
    s_waitcnt lgkmcnt(0)
    v_cmp_le_u32 vcc, 4, v4
    s_cbranch_vccnz sw_220
    s_waitcnt vmcnt(9)
    s_mov_b32 m0, 73728
    s_add_u32 s8, s8, 1024
    s_addc_u32 s9, s9, 0
    global_load_lds_dwordx4 v10, s[8:9] nt
    s_waitcnt vmcnt(9)
    ds_write_b32 v253, v225 offset:68
    s_mov_b32 m0, 74752
    s_add_u32 s8, s8, 1024
    s_addc_u32 s9, s9, 0
    global_load_lds_dwordx4 v10, s[8:9] nt
    ds_read_b32 v4, v253 offset:56
    s_waitcnt lgkmcnt(0)
    v_cmp_le_u32 vcc, 4, v4
    s_cbranch_vccnz sw_222
    s_waitcnt vmcnt(9)
    s_mov_b32 m0, 75776
    s_add_u32 s8, s8, 1024
    s_addc_u32 s9, s9, 0
    global_load_lds_dwordx4 v10, s[8:9] nt
    s_waitcnt vmcnt(9)
    s_mov_b32 m0, 76800
    s_add_u32 s8, s8, 1024
    s_addc_u32 s9, s9, 0
    global_load_lds_dwordx4 v10, s[8:9] nt
    ds_read_b32 v4, v253 offset:56
    s_waitcnt lgkmcnt(0)
    v_cmp_le_u32 vcc, 4, v4
    s_cbranch_vccnz sw_224
    s_waitcnt vmcnt(9)
    s_mov_b32 m0, 77824
    s_add_u32 s8, s8, 1024
    s_addc_u32 s9, s9, 0
    global_load_lds_dwordx4 v10, s[8:9] nt
    s_waitcnt vmcnt(9)
    s_mov_b32 m0, 78848
    s_add_u32 s8, s8, 1024
    s_addc_u32 s9, s9, 0
    global_load_lds_dwordx4 v10, s[8:9] nt
    ds_read_b32 v4, v253 offset:56
    s_waitcnt lgkmcnt(0)
    v_cmp_le_u32 vcc, 4, v4
    s_cbranch_vccnz sw_226
    s_waitcnt vmcnt(9)
    s_mov_b32 m0, 79872
    s_add_u32 s8, s8, 1024
    s_addc_u32 s9, s9, 0
    global_load_lds_dwordx4 v10, s[8:9] nt
    s_waitcnt vmcnt(9)
    s_mov_b32 m0, 80896
    s_add_u32 s8, s8, 1024
    s_addc_u32 s9, s9, 0
    global_load_lds_dwordx4 v10, s[8:9] nt
    ds_read_b32 v4, v253 offset:56
    s_waitcnt lgkmcnt(0)
    v_cmp_le_u32 vcc, 4, v4
    s_cbranch_vccnz sw_228
    s_waitcnt vmcnt(9)
    s_mov_b32 m0, 81920
    s_add_u32 s8, s8, 1024
    s_addc_u32 s9, s9, 0
    global_load_lds_dwordx4 v10, s[8:9] nt
    s_waitcnt vmcnt(9)
    s_mov_b32 m0, 82944
    s_add_u32 s8, s8, 1024
    s_addc_u32 s9, s9, 0
    global_load_lds_dwordx4 v10, s[8:9] nt
    ds_read_b32 v4, v253 offset:56
    s_waitcnt lgkmcnt(0)
    v_cmp_le_u32 vcc, 4, v4
    s_cbranch_vccnz sw_230
    s_waitcnt vmcnt(9)
    s_mov_b32 m0, 83968
    s_add_u32 s8, s8, 1024
    s_addc_u32 s9, s9, 0
    global_load_lds_dwordx4 v10, s[8:9] nt
    s_waitcnt vmcnt(9)
    s_mov_b32 m0, 84992
    s_add_u32 s8, s8, 1024
    s_addc_u32 s9, s9, 0
    global_load_lds_dwordx4 v10, s[8:9] nt
    ds_read_b32 v4, v253 offset:56
    s_waitcnt lgkmcnt(0)
    v_cmp_le_u32 vcc, 4, v4
    s_cbranch_vccnz sw_232
    s_waitcnt vmcnt(9)
    s_mov_b32 m0, 86016
    s_add_u32 s8, s8, 1024
    s_addc_u32 s9, s9, 0
    global_load_lds_dwordx4 v10, s[8:9] nt
    s_waitcnt vmcnt(9)
    s_mov_b32 m0, 87040
    s_add_u32 s8, s8, 1024
    s_addc_u32 s9, s9, 0
    global_load_lds_dwordx4 v10, s[8:9] nt
    ds_read_b32 v4, v253 offset:56
    s_waitcnt lgkmcnt(0)
    v_cmp_le_u32 vcc, 4, v4
    s_cbranch_vccnz sw_234
    s_waitcnt vmcnt(9)
    s_mov_b32 m0, 88064
    s_add_u32 s8, s8, 1024
    s_addc_u32 s9, s9, 0
    global_load_lds_dwordx4 v10, s[8:9] nt
    s_waitcnt vmcnt(9)
    s_mov_b32 m0, 89088
    s_add_u32 s8, s8, 1024
    s_addc_u32 s9, s9, 0
    global_load_lds_dwordx4 v10, s[8:9] nt
    ds_read_b32 v4, v253 offset:56
    s_waitcnt lgkmcnt(0)
    v_cmp_le_u32 vcc, 4, v4
    s_cbranch_vccnz sw_236
    s_waitcnt vmcnt(9)
    s_mov_b32 m0, 90112
    s_add_u32 s8, s8, 1024
    s_addc_u32 s9, s9, 0
    global_load_lds_dwordx4 v10, s[8:9] nt
    s_waitcnt vmcnt(9)
    s_mov_b32 m0, 91136
    s_add_u32 s8, s8, 1024
    s_addc_u32 s9, s9, 0
    global_load_lds_dwordx4 v10, s[8:9] nt
    ds_read_b32 v4, v253 offset:56
    s_waitcnt lgkmcnt(0)
    v_cmp_le_u32 vcc, 4, v4
    s_cbranch_vccnz sw_238
    s_waitcnt vmcnt(9)
    s_mov_b32 m0, 92160
    s_add_u32 s8, s8, 1024
    s_addc_u32 s9, s9, 0
    global_load_lds_dwordx4 v10, s[8:9] nt
    s_waitcnt vmcnt(9)
    s_mov_b32 m0, 93184
    s_add_u32 s8, s8, 1024
    s_addc_u32 s9, s9, 0
    global_load_lds_dwordx4 v10, s[8:9] nt
    ds_read_b32 v4, v253 offset:56
    s_waitcnt lgkmcnt(0)
    v_cmp_le_u32 vcc, 4, v4
    s_cbranch_vccnz sw_240
    s_waitcnt vmcnt(9)
    s_mov_b32 m0, 94208
    s_add_u32 s8, s8, 1024
    s_addc_u32 s9, s9, 0
    global_load_lds_dwordx4 v10, s[8:9] nt
    s_waitcnt vmcnt(9)
    s_mov_b32 m0, 95232
    s_add_u32 s8, s8, 1024
    s_addc_u32 s9, s9, 0
    global_load_lds_dwordx4 v10, s[8:9] nt
    ds_read_b32 v4, v253 offset:56
    s_waitcnt lgkmcnt(0)
    v_cmp_le_u32 vcc, 4, v4
    s_cbranch_vccnz sw_242
    s_waitcnt vmcnt(9)
    s_mov_b32 m0, 96256
    s_add_u32 s8, s8, 1024
    s_addc_u32 s9, s9, 0
    global_load_lds_dwordx4 v10, s[8:9] nt
    s_waitcnt vmcnt(9)
    s_mov_b32 m0, 97280
    s_add_u32 s8, s8, 1024
    s_addc_u32 s9, s9, 0
    global_load_lds_dwordx4 v10, s[8:9] nt
    s_branch swe_244
sw_180:
    s_waitcnt vmcnt(27)
    s_mov_b32 m0, 32768
    s_nop 0
    global_load_lds_dwordx4 v10, s[6:7] nt
sw_181:
    s_waitcnt vmcnt(27)
    s_mov_b32 m0, 33792
    s_add_u32 s6, s6, 1024
    s_addc_u32 s7, s7, 0
    global_load_lds_dwordx4 v10, s[6:7] nt
sw_182:
    s_waitcnt vmcnt(27)
    s_mov_b32 m0, 34816
    s_add_u32 s6, s6, 1024
    s_addc_u32 s7, s7, 0
    global_load_lds_dwordx4 v10, s[6:7] nt
sw_183:
    s_waitcnt vmcnt(27)
    s_mov_b32 m0, 35840
    s_add_u32 s6, s6, 1024
    s_addc_u32 s7, s7, 0
    global_load_lds_dwordx4 v10, s[6:7] nt
sw_184:
    s_waitcnt vmcnt(27)
    s_mov_b32 m0, 36864
    s_add_u32 s6, s6, 1024
    s_addc_u32 s7, s7, 0
    global_load_lds_dwordx4 v10, s[6:7] nt
sw_185:
    s_waitcnt vmcnt(27)
    s_mov_b32 m0, 37888
    s_add_u32 s6, s6, 1024
    s_addc_u32 s7, s7, 0
    global_load_lds_dwordx4 v10, s[6:7] nt
sw_186:
    s_waitcnt vmcnt(27)
    s_mov_b32 m0, 38912
    s_add_u32 s6, s6, 1024
    s_addc_u32 s7, s7, 0
    global_load_lds_dwordx4 v10, s[6:7] nt
sw_187:
    s_waitcnt vmcnt(27)
    s_mov_b32 m0, 39936
    s_add_u32 s6, s6, 1024
    s_addc_u32 s7, s7, 0
    global_load_lds_dwordx4 v10, s[6:7] nt
sw_188:
    s_waitcnt vmcnt(27)
    s_mov_b32 m0, 40960
    s_add_u32 s6, s6, 1024
    s_addc_u32 s7, s7, 0
    global_load_lds_dwordx4 v10, s[6:7] nt
sw_189:
    s_waitcnt vmcnt(27)
    s_mov_b32 m0, 41984
    s_add_u32 s6, s6, 1024
    s_addc_u32 s7, s7, 0
    global_load_lds_dwordx4 v10, s[6:7] nt
sw_190:
    s_waitcnt vmcnt(27)
    s_mov_b32 m0, 43008
    s_add_u32 s6, s6, 1024
    s_addc_u32 s7, s7, 0
    global_load_lds_dwordx4 v10, s[6:7] nt
sw_191:
    s_waitcnt vmcnt(27)
    s_mov_b32 m0, 44032
    s_add_u32 s6, s6, 1024
    s_addc_u32 s7, s7, 0
    global_load_lds_dwordx4 v10, s[6:7] nt
sw_192:
    s_waitcnt vmcnt(27)
    s_mov_b32 m0, 45056
    s_add_u32 s6, s6, 1024
    s_addc_u32 s7, s7, 0
    global_load_lds_dwordx4 v10, s[6:7] nt
sw_193:
    s_waitcnt vmcnt(27)
    s_mov_b32 m0, 46080
    s_add_u32 s6, s6, 1024
    s_addc_u32 s7, s7, 0
    global_load_lds_dwordx4 v10, s[6:7] nt
sw_194:
    s_waitcnt vmcnt(27)
    s_mov_b32 m0, 47104
    s_add_u32 s6, s6, 1024
    s_addc_u32 s7, s7, 0
    global_load_lds_dwordx4 v10, s[6:7] nt
sw_195:
    s_waitcnt vmcnt(27)
    s_mov_b32 m0, 48128
    s_add_u32 s6, s6, 1024
    s_addc_u32 s7, s7, 0
    global_load_lds_dwordx4 v10, s[6:7] nt
sw_196:
    s_waitcnt vmcnt(27)
    s_mov_b32 m0, 49152
    s_add_u32 s6, s6, 1024
    s_addc_u32 s7, s7, 0
    global_load_lds_dwordx4 v10, s[6:7] nt
sw_197:
    s_waitcnt vmcnt(27)
    s_mov_b32 m0, 50176
    s_add_u32 s6, s6, 1024
    s_addc_u32 s7, s7, 0
    global_load_lds_dwordx4 v10, s[6:7] nt
sw_198:
    s_waitcnt vmcnt(27)
    s_mov_b32 m0, 51200
    s_add_u32 s6, s6, 1024
    s_addc_u32 s7, s7, 0
    global_load_lds_dwordx4 v10, s[6:7] nt
sw_199:
    s_waitcnt vmcnt(27)
    s_mov_b32 m0, 52224
    s_add_u32 s6, s6, 1024
    s_addc_u32 s7, s7, 0
    global_load_lds_dwordx4 v10, s[6:7] nt
sw_200:
    s_waitcnt vmcnt(27)
    s_mov_b32 m0, 53248
    s_add_u32 s6, s6, 1024
    s_addc_u32 s7, s7, 0
    global_load_lds_dwordx4 v10, s[6:7] nt
sw_201:
    s_waitcnt vmcnt(27)
    s_mov_b32 m0, 54272
    s_add_u32 s6, s6, 1024
    s_addc_u32 s7, s7, 0
    global_load_lds_dwordx4 v10, s[6:7] nt
sw_202:
    s_waitcnt vmcnt(27)
    s_mov_b32 m0, 55296
    s_add_u32 s6, s6, 1024
    s_addc_u32 s7, s7, 0
    global_load_lds_dwordx4 v10, s[6:7] nt
sw_203:
    s_waitcnt vmcnt(27)
    s_mov_b32 m0, 56320
    s_add_u32 s6, s6, 1024
    s_addc_u32 s7, s7, 0
    global_load_lds_dwordx4 v10, s[6:7] nt
sw_204:
    s_waitcnt vmcnt(27)
    s_mov_b32 m0, 57344
    s_add_u32 s6, s6, 1024
    s_addc_u32 s7, s7, 0
    global_load_lds_dwordx4 v10, s[6:7] nt
sw_205:
    s_waitcnt vmcnt(27)
    s_mov_b32 m0, 58368
    s_add_u32 s6, s6, 1024
    s_addc_u32 s7, s7, 0
    global_load_lds_dwordx4 v10, s[6:7] nt
sw_206:
    s_waitcnt vmcnt(27)
    s_mov_b32 m0, 59392
    s_add_u32 s6, s6, 1024
    s_addc_u32 s7, s7, 0
    global_load_lds_dwordx4 v10, s[6:7] nt
sw_207:
    s_waitcnt vmcnt(27)
    ds_write_b32 v253, v225 offset:64
    s_mov_b32 m0, 60416
    s_add_u32 s6, s6, 1024
    s_addc_u32 s7, s7, 0
    global_load_lds_dwordx4 v10, s[6:7] nt
sw_208:
    s_waitcnt vmcnt(27)
    s_mov_b32 m0, 61440
    s_add_u32 s6, s6, 1024
    s_addc_u32 s7, s7, 0
    global_load_lds_dwordx4 v10, s[6:7] nt
sw_209:
    s_waitcnt vmcnt(27)
    s_mov_b32 m0, 62464
    s_add_u32 s6, s6, 1024
    s_addc_u32 s7, s7, 0
    global_load_lds_dwordx4 v10, s[6:7] nt
sw_210:
    s_waitcnt vmcnt(27)
    s_mov_b32 m0, 63488
    s_add_u32 s6, s6, 1024
    s_addc_u32 s7, s7, 0
    global_load_lds_dwordx4 v10, s[6:7] nt
sw_211:
    s_waitcnt vmcnt(27)
    s_mov_b32 m0, 64512
    s_add_u32 s6, s6, 1024
    s_addc_u32 s7, s7, 0
    global_load_lds_dwordx4 v10, s[6:7] nt
sw_212:
    s_waitcnt vmcnt(27)
    s_mov_b32 m0, 65536
    s_nop 0
    global_load_lds_dwordx4 v10, s[8:9] nt
sw_213:
    s_waitcnt vmcnt(27)
    s_mov_b32 m0, 66560
    s_add_u32 s8, s8, 1024
    s_addc_u32 s9, s9, 0
    global_load_lds_dwordx4 v10, s[8:9] nt
sw_214:
    s_waitcnt vmcnt(27)
    s_mov_b32 m0, 67584
    s_add_u32 s8, s8, 1024
    s_addc_u32 s9, s9, 0
    global_load_lds_dwordx4 v10, s[8:9] nt
sw_215:
    s_waitcnt vmcnt(27)
    s_mov_b32 m0, 68608
    s_add_u32 s8, s8, 1024
    s_addc_u32 s9, s9, 0
    global_load_lds_dwordx4 v10, s[8:9] nt
sw_216:
    s_waitcnt vmcnt(27)
    s_mov_b32 m0, 69632
    s_add_u32 s8, s8, 1024
    s_addc_u32 s9, s9, 0
    global_load_lds_dwordx4 v10, s[8:9] nt
sw_217:
    s_waitcnt vmcnt(27)
    s_mov_b32 m0, 70656
    s_add_u32 s8, s8, 1024
    s_addc_u32 s9, s9, 0
    global_load_lds_dwordx4 v10, s[8:9] nt
sw_218:
    s_waitcnt vmcnt(27)
    s_mov_b32 m0, 71680
    s_add_u32 s8, s8, 1024
    s_addc_u32 s9, s9, 0
    global_load_lds_dwordx4 v10, s[8:9] nt
sw_219:
    s_waitcnt vmcnt(27)
    s_mov_b32 m0, 72704
    s_add_u32 s8, s8, 1024
    s_addc_u32 s9, s9, 0
    global_load_lds_dwordx4 v10, s[8:9] nt
sw_220:
    s_waitcnt vmcnt(27)
    s_mov_b32 m0, 73728
    s_add_u32 s8, s8, 1024
    s_addc_u32 s9, s9, 0
    global_load_lds_dwordx4 v10, s[8:9] nt
sw_221:
    s_waitcnt vmcnt(27)
    s_mov_b32 m0, 74752
    s_add_u32 s8, s8, 1024
    s_addc_u32 s9, s9, 0
    global_load_lds_dwordx4 v10, s[8:9] nt
sw_222:
    s_waitcnt vmcnt(27)
    s_mov_b32 m0, 75776
    s_add_u32 s8, s8, 1024
    s_addc_u32 s9, s9, 0
    global_load_lds_dwordx4 v10, s[8:9] nt
sw_223:
    s_waitcnt vmcnt(27)
    s_mov_b32 m0, 76800
    s_add_u32 s8, s8, 1024
    s_addc_u32 s9, s9, 0
    global_load_lds_dwordx4 v10, s[8:9] nt
sw_224:
    s_waitcnt vmcnt(27)
    s_mov_b32 m0, 77824
    s_add_u32 s8, s8, 1024
    s_addc_u32 s9, s9, 0
    global_load_lds_dwordx4 v10, s[8:9] nt
sw_225:
    s_waitcnt vmcnt(27)
    s_mov_b32 m0, 78848
    s_add_u32 s8, s8, 1024
    s_addc_u32 s9, s9, 0
    global_load_lds_dwordx4 v10, s[8:9] nt
sw_226:
    s_waitcnt vmcnt(27)
    s_mov_b32 m0, 79872
    s_add_u32 s8, s8, 1024
    s_addc_u32 s9, s9, 0
    global_load_lds_dwordx4 v10, s[8:9] nt
sw_227:
    s_waitcnt vmcnt(27)
    s_mov_b32 m0, 80896
    s_add_u32 s8, s8, 1024
    s_addc_u32 s9, s9, 0
    global_load_lds_dwordx4 v10, s[8:9] nt
sw_228:
    s_waitcnt vmcnt(27)
    s_mov_b32 m0, 81920
    s_add_u32 s8, s8, 1024
    s_addc_u32 s9, s9, 0
    global_load_lds_dwordx4 v10, s[8:9] nt
sw_229:
    s_waitcnt vmcnt(27)
    s_mov_b32 m0, 82944
    s_add_u32 s8, s8, 1024
    s_addc_u32 s9, s9, 0
    global_load_lds_dwordx4 v10, s[8:9] nt
sw_230:
    s_waitcnt vmcnt(27)
    s_mov_b32 m0, 83968
    s_add_u32 s8, s8, 1024
    s_addc_u32 s9, s9, 0
    global_load_lds_dwordx4 v10, s[8:9] nt
sw_231:
    s_waitcnt vmcnt(27)
    s_mov_b32 m0, 84992
    s_add_u32 s8, s8, 1024
    s_addc_u32 s9, s9, 0
    global_load_lds_dwordx4 v10, s[8:9] nt
sw_232:
    s_waitcnt vmcnt(27)
    s_mov_b32 m0, 86016
    s_add_u32 s8, s8, 1024
    s_addc_u32 s9, s9, 0
    global_load_lds_dwordx4 v10, s[8:9] nt
sw_233:
    s_waitcnt vmcnt(27)
    s_mov_b32 m0, 87040
    s_add_u32 s8, s8, 1024
    s_addc_u32 s9, s9, 0
    global_load_lds_dwordx4 v10, s[8:9] nt
sw_234:
    s_waitcnt vmcnt(27)
    s_mov_b32 m0, 88064
    s_add_u32 s8, s8, 1024
    s_addc_u32 s9, s9, 0
    global_load_lds_dwordx4 v10, s[8:9] nt
sw_235:
    s_waitcnt vmcnt(27)
    s_mov_b32 m0, 89088
    s_add_u32 s8, s8, 1024
    s_addc_u32 s9, s9, 0
    global_load_lds_dwordx4 v10, s[8:9] nt
sw_236:
    s_waitcnt vmcnt(27)
    s_mov_b32 m0, 90112
    s_add_u32 s8, s8, 1024
    s_addc_u32 s9, s9, 0
    global_load_lds_dwordx4 v10, s[8:9] nt
sw_237:
    s_waitcnt vmcnt(27)
    s_mov_b32 m0, 91136
    s_add_u32 s8, s8, 1024
    s_addc_u32 s9, s9, 0
    global_load_lds_dwordx4 v10, s[8:9] nt
sw_238:
    s_waitcnt vmcnt(27)
    s_mov_b32 m0, 92160
    s_add_u32 s8, s8, 1024
    s_addc_u32 s9, s9, 0
    global_load_lds_dwordx4 v10, s[8:9] nt
sw_239:
    s_waitcnt vmcnt(27)
    ds_write_b32 v253, v225 offset:68
    s_mov_b32 m0, 93184
    s_add_u32 s8, s8, 1024
    s_addc_u32 s9, s9, 0
    global_load_lds_dwordx4 v10, s[8:9] nt
sw_240:
    s_waitcnt vmcnt(27)
    s_mov_b32 m0, 94208
    s_add_u32 s8, s8, 1024
    s_addc_u32 s9, s9, 0
    global_load_lds_dwordx4 v10, s[8:9] nt
sw_241:
    s_waitcnt vmcnt(27)
    s_mov_b32 m0, 95232
    s_add_u32 s8, s8, 1024
    s_addc_u32 s9, s9, 0
    global_load_lds_dwordx4 v10, s[8:9] nt
sw_242:
    s_waitcnt vmcnt(27)
    s_mov_b32 m0, 96256
    s_add_u32 s8, s8, 1024
    s_addc_u32 s9, s9, 0
    global_load_lds_dwordx4 v10, s[8:9] nt
sw_243:
    s_waitcnt vmcnt(27)
    s_mov_b32 m0, 97280
    s_add_u32 s8, s8, 1024
    s_addc_u32 s9, s9, 0
    global_load_lds_dwordx4 v10, s[8:9] nt
swe_244:
    s_mov_b32 m0, 98304
    s_nop 0
    global_load_lds_dwordx4 v11, s[12:13] nt
    s_mov_b32 m0, 99328
    s_add_u32 s12, s12, 8192
    s_addc_u32 s13, s13, 0
    global_load_lds_dwordx4 v11, s[12:13] nt
    s_mov_b32 m0, 100352
    s_add_u32 s12, s12, 8192
    s_addc_u32 s13, s13, 0
    global_load_lds_dwordx4 v11, s[12:13] nt
    s_mov_b32 m0, 101376
    s_add_u32 s12, s12, 8192
    s_addc_u32 s13, s13, 0
    global_load_lds_dwordx4 v11, s[12:13] nt
    s_mov_b32 m0, 102400
    s_add_u32 s12, s12, 8192
    s_addc_u32 s13, s13, 0
    global_load_lds_dwordx4 v11, s[12:13] nt
    s_mov_b32 m0, 103424
    s_add_u32 s12, s12, 8192
    s_addc_u32 s13, s13, 0
    global_load_lds_dwordx4 v11, s[12:13] nt
    s_mov_b32 m0, 104448
    s_add_u32 s12, s12, 8192
    s_addc_u32 s13, s13, 0
    global_load_lds_dwordx4 v11, s[12:13] nt
    s_mov_b32 m0, 105472
    s_add_u32 s12, s12, 8192
    s_addc_u32 s13, s13, 0
    global_load_lds_dwordx4 v11, s[12:13] nt
    s_waitcnt vmcnt(40)
    ds_write_b32 v253, v225 offset:68
    s_waitcnt vmcnt(8)
    ds_write_b32 v253, v225 offset:72
    ds_read_b32 v4, v253 offset:4
    s_waitcnt lgkmcnt(0)
    v_cmp_le_u32 vcc, 4, v4
    s_cbranch_vccnz sw_245
    s_waitcnt vmcnt(23)
    s_mov_b32 m0, 106496
    s_add_u32 s12, s12, 8192
    s_addc_u32 s13, s13, 0
    global_load_lds_dwordx4 v11, s[12:13] nt
    s_waitcnt vmcnt(23)
    s_mov_b32 m0, 107520
    s_add_u32 s12, s12, 8192
    s_addc_u32 s13, s13, 0
    global_load_lds_dwordx4 v11, s[12:13] nt
    ds_read_b32 v4, v253 offset:4
    s_waitcnt lgkmcnt(0)
    v_cmp_le_u32 vcc, 4, v4
    s_cbranch_vccnz sw_247
    s_waitcnt vmcnt(23)
    s_mov_b32 m0, 108544
    s_add_u32 s12, s12, 8192
    s_addc_u32 s13, s13, 0
    global_load_lds_dwordx4 v11, s[12:13] nt
    s_waitcnt vmcnt(23)
    s_mov_b32 m0, 109568
    s_add_u32 s12, s12, 8192
    s_addc_u32 s13, s13, 0
    global_load_lds_dwordx4 v11, s[12:13] nt
    ds_read_b32 v4, v253 offset:4
    s_waitcnt lgkmcnt(0)
    v_cmp_le_u32 vcc, 4, v4
    s_cbranch_vccnz sw_249
    s_waitcnt vmcnt(23)
    s_mov_b32 m0, 110592
    s_add_u32 s12, s12, 8192
    s_addc_u32 s13, s13, 0
    global_load_lds_dwordx4 v11, s[12:13] nt
    s_waitcnt vmcnt(23)
    s_mov_b32 m0, 111616
    s_add_u32 s12, s12, 8192
    s_addc_u32 s13, s13, 0
    global_load_lds_dwordx4 v11, s[12:13] nt
    ds_read_b32 v4, v253 offset:4
    s_waitcnt lgkmcnt(0)
    v_cmp_le_u32 vcc, 4, v4
    s_cbranch_vccnz sw_251
    s_waitcnt vmcnt(23)
    s_mov_b32 m0, 112640
    s_add_u32 s12, s12, 8192
    s_addc_u32 s13, s13, 0
    global_load_lds_dwordx4 v11, s[12:13] nt
    s_waitcnt vmcnt(23)
    s_mov_b32 m0, 113664
    s_add_u32 s12, s12, 8192
    s_addc_u32 s13, s13, 0
    global_load_lds_dwordx4 v11, s[12:13] nt
    ds_read_b32 v4, v253 offset:4
    s_waitcnt lgkmcnt(0)
    v_cmp_le_u32 vcc, 4, v4
    s_cbranch_vccnz sw_253
    s_waitcnt vmcnt(23)
    s_mov_b32 m0, 114688
    s_add_u32 s12, s12, 8192
    s_addc_u32 s13, s13, 0
    global_load_lds_dwordx4 v11, s[12:13] nt
    s_waitcnt vmcnt(23)
    s_mov_b32 m0, 115712
    s_add_u32 s12, s12, 8192
    s_addc_u32 s13, s13, 0
    global_load_lds_dwordx4 v11, s[12:13] nt
    ds_read_b32 v4, v253 offset:4
    s_waitcnt lgkmcnt(0)
    v_cmp_le_u32 vcc, 4, v4
    s_cbranch_vccnz sw_255
    s_waitcnt vmcnt(23)
    s_mov_b32 m0, 116736
    s_add_u32 s12, s12, 8192
    s_addc_u32 s13, s13, 0
    global_load_lds_dwordx4 v11, s[12:13] nt
    s_waitcnt vmcnt(23)
    s_mov_b32 m0, 117760
    s_add_u32 s12, s12, 8192
    s_addc_u32 s13, s13, 0
    global_load_lds_dwordx4 v11, s[12:13] nt
    ds_read_b32 v4, v253 offset:4
    s_waitcnt lgkmcnt(0)
    v_cmp_le_u32 vcc, 4, v4
    s_cbranch_vccnz sw_257
    s_waitcnt vmcnt(23)
    s_mov_b32 m0, 118784
    s_add_u32 s12, s12, 8192
    s_addc_u32 s13, s13, 0
    global_load_lds_dwordx4 v11, s[12:13] nt
    s_waitcnt vmcnt(23)
    s_mov_b32 m0, 119808
    s_add_u32 s12, s12, 8192
    s_addc_u32 s13, s13, 0
    global_load_lds_dwordx4 v11, s[12:13] nt
    ds_read_b32 v4, v253 offset:4
    s_waitcnt lgkmcnt(0)
    v_cmp_le_u32 vcc, 4, v4
    s_cbranch_vccnz sw_259
    s_waitcnt vmcnt(23)
    s_mov_b32 m0, 120832
    s_add_u32 s12, s12, 8192
    s_addc_u32 s13, s13, 0
    global_load_lds_dwordx4 v11, s[12:13] nt
    s_waitcnt vmcnt(23)
    ds_write_b32 v253, v225 offset:72
    s_mov_b32 m0, 121856
    s_add_u32 s12, s12, 8192
    s_addc_u32 s13, s13, 0
    global_load_lds_dwordx4 v11, s[12:13] nt
    ds_read_b32 v4, v253 offset:4
    s_waitcnt lgkmcnt(0)
    v_cmp_le_u32 vcc, 4, v4
    s_cbranch_vccnz sw_261
    s_waitcnt vmcnt(23)
    s_mov_b32 m0, 122880
    s_add_u32 s12, s12, 8192
    s_addc_u32 s13, s13, 0
    global_load_lds_dwordx4 v11, s[12:13] nt
    s_waitcnt vmcnt(23)
    s_mov_b32 m0, 123904
    s_add_u32 s12, s12, 8192
    s_addc_u32 s13, s13, 0
    global_load_lds_dwordx4 v11, s[12:13] nt
    ds_read_b32 v4, v253 offset:4
    s_waitcnt lgkmcnt(0)
    v_cmp_le_u32 vcc, 4, v4
    s_cbranch_vccnz sw_263
    s_waitcnt vmcnt(23)
    s_mov_b32 m0, 124928
    s_add_u32 s12, s12, 8192
    s_addc_u32 s13, s13, 0
    global_load_lds_dwordx4 v11, s[12:13] nt
    s_waitcnt vmcnt(23)
    s_mov_b32 m0, 125952
    s_add_u32 s12, s12, 8192
    s_addc_u32 s13, s13, 0
    global_load_lds_dwordx4 v11, s[12:13] nt
    ds_read_b32 v4, v253 offset:4
    s_waitcnt lgkmcnt(0)
    v_cmp_le_u32 vcc, 4, v4
    s_cbranch_vccnz sw_265
    s_waitcnt vmcnt(23)
    s_mov_b32 m0, 126976
    s_add_u32 s12, s12, 8192
    s_addc_u32 s13, s13, 0
    global_load_lds_dwordx4 v11, s[12:13] nt
    s_waitcnt vmcnt(23)
    s_mov_b32 m0, 128000
    s_add_u32 s12, s12, 8192
    s_addc_u32 s13, s13, 0
    global_load_lds_dwordx4 v11, s[12:13] nt
    ds_read_b32 v4, v253 offset:4
    s_waitcnt lgkmcnt(0)
    v_cmp_le_u32 vcc, 4, v4
    s_cbranch_vccnz sw_267
    s_waitcnt vmcnt(23)
    s_mov_b32 m0, 129024
    s_add_u32 s12, s12, 8192
    s_addc_u32 s13, s13, 0
    global_load_lds_dwordx4 v11, s[12:13] nt
    s_waitcnt vmcnt(23)
    s_mov_b32 m0, 130048
    s_add_u32 s12, s12, 8192
    s_addc_u32 s13, s13, 0
    global_load_lds_dwordx4 v11, s[12:13] nt
    s_branch swe_269
sw_245:
    s_waitcnt vmcnt(9)
    s_mov_b32 m0, 106496
    s_add_u32 s12, s12, 8192
    s_addc_u32 s13, s13, 0
    global_load_lds_dwordx4 v11, s[12:13] nt
sw_246:
    s_waitcnt vmcnt(9)
    ds_write_b32 v253, v225 offset:72
    s_mov_b32 m0, 107520
    s_add_u32 s12, s12, 8192
    s_addc_u32 s13, s13, 0
    global_load_lds_dwordx4 v11, s[12:13] nt
sw_247:
    s_waitcnt vmcnt(9)
    s_mov_b32 m0, 108544
    s_add_u32 s12, s12, 8192
    s_addc_u32 s13, s13, 0
    global_load_lds_dwordx4 v11, s[12:13] nt
sw_248:
    s_waitcnt vmcnt(9)
    s_mov_b32 m0, 109568
    s_add_u32 s12, s12, 8192
    s_addc_u32 s13, s13, 0
    global_load_lds_dwordx4 v11, s[12:13] nt
sw_249:
    s_waitcnt vmcnt(9)
    s_mov_b32 m0, 110592
    s_add_u32 s12, s12, 8192
    s_addc_u32 s13, s13, 0
    global_load_lds_dwordx4 v11, s[12:13] nt
sw_250:
    s_waitcnt vmcnt(9)
    s_mov_b32 m0, 111616
    s_add_u32 s12, s12, 8192
    s_addc_u32 s13, s13, 0
    global_load_lds_dwordx4 v11, s[12:13] nt
sw_251:
    s_waitcnt vmcnt(9)
    s_mov_b32 m0, 112640
    s_add_u32 s12, s12, 8192
    s_addc_u32 s13, s13, 0
    global_load_lds_dwordx4 v11, s[12:13] nt
sw_252:
    s_waitcnt vmcnt(9)
    s_mov_b32 m0, 113664
    s_add_u32 s12, s12, 8192
    s_addc_u32 s13, s13, 0
    global_load_lds_dwordx4 v11, s[12:13] nt
sw_253:
    s_waitcnt vmcnt(9)
    s_mov_b32 m0, 114688
    s_add_u32 s12, s12, 8192
    s_addc_u32 s13, s13, 0
    global_load_lds_dwordx4 v11, s[12:13] nt
sw_254:
    s_waitcnt vmcnt(9)
    s_mov_b32 m0, 115712
    s_add_u32 s12, s12, 8192
    s_addc_u32 s13, s13, 0
    global_load_lds_dwordx4 v11, s[12:13] nt
sw_255:
    s_waitcnt vmcnt(9)
    s_mov_b32 m0, 116736
    s_add_u32 s12, s12, 8192
    s_addc_u32 s13, s13, 0
    global_load_lds_dwordx4 v11, s[12:13] nt
sw_256:
    s_waitcnt vmcnt(9)
    s_mov_b32 m0, 117760
    s_add_u32 s12, s12, 8192
    s_addc_u32 s13, s13, 0
    global_load_lds_dwordx4 v11, s[12:13] nt
sw_257:
    s_waitcnt vmcnt(9)
    s_mov_b32 m0, 118784
    s_add_u32 s12, s12, 8192
    s_addc_u32 s13, s13, 0
    global_load_lds_dwordx4 v11, s[12:13] nt
sw_258:
    s_waitcnt vmcnt(9)
    s_mov_b32 m0, 119808
    s_add_u32 s12, s12, 8192
    s_addc_u32 s13, s13, 0
    global_load_lds_dwordx4 v11, s[12:13] nt
sw_259:
    s_waitcnt vmcnt(9)
    s_mov_b32 m0, 120832
    s_add_u32 s12, s12, 8192
    s_addc_u32 s13, s13, 0
    global_load_lds_dwordx4 v11, s[12:13] nt
sw_260:
    s_waitcnt vmcnt(9)
    s_mov_b32 m0, 121856
    s_add_u32 s12, s12, 8192
    s_addc_u32 s13, s13, 0
    global_load_lds_dwordx4 v11, s[12:13] nt
sw_261:
    s_waitcnt vmcnt(9)
    s_mov_b32 m0, 122880
    s_add_u32 s12, s12, 8192
    s_addc_u32 s13, s13, 0
    global_load_lds_dwordx4 v11, s[12:13] nt
sw_262:
    s_waitcnt vmcnt(9)
    s_mov_b32 m0, 123904
    s_add_u32 s12, s12, 8192
    s_addc_u32 s13, s13, 0
    global_load_lds_dwordx4 v11, s[12:13] nt
sw_263:
    s_waitcnt vmcnt(9)
    s_mov_b32 m0, 124928
    s_add_u32 s12, s12, 8192
    s_addc_u32 s13, s13, 0
    global_load_lds_dwordx4 v11, s[12:13] nt
sw_264:
    s_waitcnt vmcnt(9)
    s_mov_b32 m0, 125952
    s_add_u32 s12, s12, 8192
    s_addc_u32 s13, s13, 0
    global_load_lds_dwordx4 v11, s[12:13] nt
sw_265:
    s_waitcnt vmcnt(9)
    s_mov_b32 m0, 126976
    s_add_u32 s12, s12, 8192
    s_addc_u32 s13, s13, 0
    global_load_lds_dwordx4 v11, s[12:13] nt
sw_266:
    s_waitcnt vmcnt(9)
    s_mov_b32 m0, 128000
    s_add_u32 s12, s12, 8192
    s_addc_u32 s13, s13, 0
    global_load_lds_dwordx4 v11, s[12:13] nt
sw_267:
    s_waitcnt vmcnt(9)
    s_mov_b32 m0, 129024
    s_add_u32 s12, s12, 8192
    s_addc_u32 s13, s13, 0
    global_load_lds_dwordx4 v11, s[12:13] nt
sw_268:
    s_waitcnt vmcnt(9)
    s_mov_b32 m0, 130048
    s_add_u32 s12, s12, 8192
    s_addc_u32 s13, s13, 0
    global_load_lds_dwordx4 v11, s[12:13] nt
swe_269:
    s_cmp_ge_u32 s32, 28
    s_cbranch_scc1 L_ldshort
lw_270:
    ds_read_b32 v4, v253 offset:20
    s_waitcnt lgkmcnt(0)
    v_cmp_gt_u32 vcc, 4, v4
    s_cbranch_vccnz rt_271
    s_waitcnt vmcnt(9)
    s_mov_b32 m0, 0
    s_nop 0
    global_load_lds_dwordx4 v12, s[16:17] nt
    s_waitcnt vmcnt(9)
    s_mov_b32 m0, 1024
    s_add_u32 s16, s16, 28672
    s_addc_u32 s17, s17, 0
    global_load_lds_dwordx4 v12, s[16:17] nt
    s_waitcnt vmcnt(9)
    s_mov_b32 m0, 2048
    s_add_u32 s16, s16, 28672
    s_addc_u32 s17, s17, 0
    global_load_lds_dwordx4 v12, s[16:17] nt
    s_waitcnt vmcnt(9)
    s_mov_b32 m0, 3072
    s_add_u32 s16, s16, 28672
    s_addc_u32 s17, s17, 0
    global_load_lds_dwordx4 v12, s[16:17] nt
    s_waitcnt vmcnt(9)
    s_mov_b32 m0, 4096
    s_add_u32 s16, s16, 28672
    s_addc_u32 s17, s17, 0
    global_load_lds_dwordx4 v12, s[16:17] nt
    s_waitcnt vmcnt(9)
    s_mov_b32 m0, 5120
    s_add_u32 s16, s16, 28672
    s_addc_u32 s17, s17, 0
    global_load_lds_dwordx4 v12, s[16:17] nt
    s_waitcnt vmcnt(9)
    s_mov_b32 m0, 6144
    s_add_u32 s16, s16, 28672
    s_addc_u32 s17, s17, 0
    global_load_lds_dwordx4 v12, s[16:17] nt
    s_waitcnt vmcnt(9)
    s_mov_b32 m0, 7168
    s_add_u32 s16, s16, 28672
    s_addc_u32 s17, s17, 0
    global_load_lds_dwordx4 v12, s[16:17] nt
    s_waitcnt vmcnt(9)
    s_mov_b32 m0, 8192
    s_add_u32 s16, s16, 28672
    s_addc_u32 s17, s17, 0
    global_load_lds_dwordx4 v12, s[16:17] nt
    s_waitcnt vmcnt(9)
    ds_write_b32 v253, v225 offset:76
    s_mov_b32 m0, 9216
    s_add_u32 s16, s16, 28672
    s_addc_u32 s17, s17, 0
    global_load_lds_dwordx4 v12, s[16:17] nt
    s_waitcnt vmcnt(9)
    s_mov_b32 m0, 10240
    s_add_u32 s16, s16, 28672
    s_addc_u32 s17, s17, 0
    global_load_lds_dwordx4 v12, s[16:17] nt
    s_waitcnt vmcnt(9)
    s_mov_b32 m0, 11264
    s_add_u32 s16, s16, 28672
    s_addc_u32 s17, s17, 0
    global_load_lds_dwordx4 v12, s[16:17] nt
    s_waitcnt vmcnt(9)
    s_mov_b32 m0, 12288
    s_add_u32 s16, s16, 28672
    s_addc_u32 s17, s17, 0
    global_load_lds_dwordx4 v12, s[16:17] nt
    s_waitcnt vmcnt(9)
    s_mov_b32 m0, 13312
    s_add_u32 s16, s16, 28672
    s_addc_u32 s17, s17, 0
    global_load_lds_dwordx4 v12, s[16:17] nt
    s_waitcnt vmcnt(9)
    s_mov_b32 m0, 14336
    s_add_u32 s16, s16, 28672
    s_addc_u32 s17, s17, 0
    global_load_lds_dwordx4 v12, s[16:17] nt
    s_waitcnt vmcnt(9)
    s_mov_b32 m0, 15360
    s_add_u32 s16, s16, 28672
    s_addc_u32 s17, s17, 0
    global_load_lds_dwordx4 v12, s[16:17] nt
    s_waitcnt vmcnt(9)
    s_mov_b32 m0, 16384
    s_add_u32 s16, s16, 28672
    s_addc_u32 s17, s17, 0
    global_load_lds_dwordx4 v12, s[16:17] nt
    s_waitcnt vmcnt(9)
    s_mov_b32 m0, 17408
    s_add_u32 s16, s16, 28672
    s_addc_u32 s17, s17, 0
    global_load_lds_dwordx4 v12, s[16:17] nt
    s_waitcnt vmcnt(9)
    s_mov_b32 m0, 18432
    s_add_u32 s16, s16, 28672
    s_addc_u32 s17, s17, 0
    global_load_lds_dwordx4 v12, s[16:17] nt
    s_waitcnt vmcnt(9)
    s_mov_b32 m0, 19456
    s_add_u32 s16, s16, 28672
    s_addc_u32 s17, s17, 0
    global_load_lds_dwordx4 v12, s[16:17] nt
    s_waitcnt vmcnt(9)
    s_mov_b32 m0, 20480
    s_add_u32 s16, s16, 28672
    s_addc_u32 s17, s17, 0
    global_load_lds_dwordx4 v12, s[16:17] nt
    s_waitcnt vmcnt(9)
    s_mov_b32 m0, 21504
    s_add_u32 s16, s16, 28672
    s_addc_u32 s17, s17, 0
    global_load_lds_dwordx4 v12, s[16:17] nt
    s_waitcnt vmcnt(9)
    s_mov_b32 m0, 22528
    s_add_u32 s16, s16, 28672
    s_addc_u32 s17, s17, 0
    global_load_lds_dwordx4 v12, s[16:17] nt
    s_waitcnt vmcnt(9)
    s_mov_b32 m0, 23552
    s_add_u32 s16, s16, 28672
    s_addc_u32 s17, s17, 0
    global_load_lds_dwordx4 v12, s[16:17] nt
    s_waitcnt vmcnt(9)
    s_mov_b32 m0, 24576
    s_add_u32 s16, s16, 28672
    s_addc_u32 s17, s17, 0
    global_load_lds_dwordx4 v12, s[16:17] nt
    s_waitcnt vmcnt(9)
    s_mov_b32 m0, 25600
    s_add_u32 s16, s16, 28672
    s_addc_u32 s17, s17, 0
    global_load_lds_dwordx4 v12, s[16:17] nt
    s_waitcnt vmcnt(9)
    s_mov_b32 m0, 26624
    s_add_u32 s16, s16, 28672
    s_addc_u32 s17, s17, 0
    global_load_lds_dwordx4 v12, s[16:17] nt
    s_waitcnt vmcnt(9)
    s_mov_b32 m0, 27648
    s_add_u32 s16, s16, 28672
    s_addc_u32 s17, s17, 0
    global_load_lds_dwordx4 v12, s[16:17] nt
    s_waitcnt vmcnt(9)
    s_mov_b32 m0, 28672
    s_add_u32 s16, s16, 28672
    s_addc_u32 s17, s17, 0
    global_load_lds_dwordx4 v12, s[16:17] nt
    s_waitcnt vmcnt(9)
    s_mov_b32 m0, 29696
    s_add_u32 s16, s16, 28672
    s_addc_u32 s17, s17, 0
    global_load_lds_dwordx4 v12, s[16:17] nt
    s_waitcnt vmcnt(9)
    s_mov_b32 m0, 30720
    s_add_u32 s16, s16, 28672
    s_addc_u32 s17, s17, 0
    global_load_lds_dwordx4 v12, s[16:17] nt
    s_waitcnt vmcnt(9)
    s_mov_b32 m0, 31744
    s_add_u32 s16, s16, 28672
    s_addc_u32 s17, s17, 0
    global_load_lds_dwordx4 v12, s[16:17] nt
lw_272:
    ds_read_b32 v4, v253 offset:60
    s_waitcnt lgkmcnt(0)
    v_cmp_gt_u32 vcc, 4, v4
    s_cbranch_vccnz rt_273
    s_waitcnt vmcnt(9)
    s_mov_b32 m0, 32768
    s_nop 0
    global_load_lds_dwordx4 v11, s[20:21] nt
    s_waitcnt vmcnt(9)
    s_mov_b32 m0, 33792
    s_add_u32 s20, s20, 8192
    s_addc_u32 s21, s21, 0
    global_load_lds_dwordx4 v11, s[20:21] nt
    s_waitcnt vmcnt(9)
    s_mov_b32 m0, 34816
    s_add_u32 s20, s20, 8192
    s_addc_u32 s21, s21, 0
    global_load_lds_dwordx4 v11, s[20:21] nt
    s_waitcnt vmcnt(9)
    s_mov_b32 m0, 35840
    s_add_u32 s20, s20, 8192
    s_addc_u32 s21, s21, 0
    global_load_lds_dwordx4 v11, s[20:21] nt
    s_waitcnt vmcnt(9)
    s_mov_b32 m0, 36864
    s_add_u32 s20, s20, 8192
    s_addc_u32 s21, s21, 0
    global_load_lds_dwordx4 v11, s[20:21] nt
    s_waitcnt vmcnt(9)
    s_mov_b32 m0, 37888
    s_add_u32 s20, s20, 8192
    s_addc_u32 s21, s21, 0
    global_load_lds_dwordx4 v11, s[20:21] nt
    s_waitcnt vmcnt(9)
    s_mov_b32 m0, 38912
    s_add_u32 s20, s20, 8192
    s_addc_u32 s21, s21, 0
    global_load_lds_dwordx4 v11, s[20:21] nt
    s_waitcnt vmcnt(9)
    s_mov_b32 m0, 39936
    s_add_u32 s20, s20, 8192
    s_addc_u32 s21, s21, 0
    global_load_lds_dwordx4 v11, s[20:21] nt
    s_waitcnt vmcnt(9)
    s_mov_b32 m0, 40960
    s_add_u32 s20, s20, 8192
    s_addc_u32 s21, s21, 0
    global_load_lds_dwordx4 v11, s[20:21] nt
    s_waitcnt vmcnt(9)
    ds_write_b32 v253, v225 offset:80
    s_mov_b32 m0, 41984
    s_add_u32 s20, s20, 8192
    s_addc_u32 s21, s21, 0
    global_load_lds_dwordx4 v11, s[20:21] nt
    s_waitcnt vmcnt(9)
    s_mov_b32 m0, 43008
    s_add_u32 s20, s20, 8192
    s_addc_u32 s21, s21, 0
    global_load_lds_dwordx4 v11, s[20:21] nt
    s_waitcnt vmcnt(9)
    s_mov_b32 m0, 44032
    s_add_u32 s20, s20, 8192
    s_addc_u32 s21, s21, 0
    global_load_lds_dwordx4 v11, s[20:21] nt
    s_waitcnt vmcnt(9)
    s_mov_b32 m0, 45056
    s_add_u32 s20, s20, 8192
    s_addc_u32 s21, s21, 0
    global_load_lds_dwordx4 v11, s[20:21] nt
    s_waitcnt vmcnt(9)
    s_mov_b32 m0, 46080
    s_add_u32 s20, s20, 8192
    s_addc_u32 s21, s21, 0
    global_load_lds_dwordx4 v11, s[20:21] nt
    s_waitcnt vmcnt(9)
    s_mov_b32 m0, 47104
    s_add_u32 s20, s20, 8192
    s_addc_u32 s21, s21, 0
    global_load_lds_dwordx4 v11, s[20:21] nt
    s_waitcnt vmcnt(9)
    s_mov_b32 m0, 48128
    s_add_u32 s20, s20, 8192
    s_addc_u32 s21, s21, 0
    global_load_lds_dwordx4 v11, s[20:21] nt
    s_waitcnt vmcnt(9)
    s_mov_b32 m0, 49152
    s_add_u32 s20, s20, 8192
    s_addc_u32 s21, s21, 0
    global_load_lds_dwordx4 v11, s[20:21] nt
    s_waitcnt vmcnt(9)
    s_mov_b32 m0, 50176
    s_add_u32 s20, s20, 8192
    s_addc_u32 s21, s21, 0
    global_load_lds_dwordx4 v11, s[20:21] nt
    s_waitcnt vmcnt(9)
    s_mov_b32 m0, 51200
    s_add_u32 s20, s20, 8192
    s_addc_u32 s21, s21, 0
    global_load_lds_dwordx4 v11, s[20:21] nt
    s_waitcnt vmcnt(9)
    s_mov_b32 m0, 52224
    s_add_u32 s20, s20, 8192
    s_addc_u32 s21, s21, 0
    global_load_lds_dwordx4 v11, s[20:21] nt
    s_waitcnt vmcnt(9)
    s_mov_b32 m0, 53248
    s_add_u32 s20, s20, 8192
    s_addc_u32 s21, s21, 0
    global_load_lds_dwordx4 v11, s[20:21] nt
    s_waitcnt vmcnt(9)
    s_mov_b32 m0, 54272
    s_add_u32 s20, s20, 8192
    s_addc_u32 s21, s21, 0
    global_load_lds_dwordx4 v11, s[20:21] nt
    s_waitcnt vmcnt(9)
    s_mov_b32 m0, 55296
    s_add_u32 s20, s20, 8192
    s_addc_u32 s21, s21, 0
    global_load_lds_dwordx4 v11, s[20:21] nt
    s_waitcnt vmcnt(9)
    s_mov_b32 m0, 56320
    s_add_u32 s20, s20, 8192
    s_addc_u32 s21, s21, 0
    global_load_lds_dwordx4 v11, s[20:21] nt
    s_waitcnt vmcnt(9)
    s_mov_b32 m0, 57344
    s_add_u32 s20, s20, 8192
    s_addc_u32 s21, s21, 0
    global_load_lds_dwordx4 v11, s[20:21] nt
    s_waitcnt vmcnt(9)
    s_mov_b32 m0, 58368
    s_add_u32 s20, s20, 8192
    s_addc_u32 s21, s21, 0
    global_load_lds_dwordx4 v11, s[20:21] nt
    s_waitcnt vmcnt(9)
    s_mov_b32 m0, 59392
    s_add_u32 s20, s20, 8192
    s_addc_u32 s21, s21, 0
    global_load_lds_dwordx4 v11, s[20:21] nt
    s_waitcnt vmcnt(9)
    s_mov_b32 m0, 60416
    s_add_u32 s20, s20, 8192
    s_addc_u32 s21, s21, 0
    global_load_lds_dwordx4 v11, s[20:21] nt
    s_waitcnt vmcnt(9)
    s_mov_b32 m0, 61440
    s_add_u32 s20, s20, 8192
    s_addc_u32 s21, s21, 0
    global_load_lds_dwordx4 v11, s[20:21] nt
    s_waitcnt vmcnt(9)
    s_mov_b32 m0, 62464
    s_add_u32 s20, s20, 8192
    s_addc_u32 s21, s21, 0
    global_load_lds_dwordx4 v11, s[20:21] nt
    s_waitcnt vmcnt(9)
    s_mov_b32 m0, 63488
    s_add_u32 s20, s20, 8192
    s_addc_u32 s21, s21, 0
    global_load_lds_dwordx4 v11, s[20:21] nt
    s_waitcnt vmcnt(9)
    s_mov_b32 m0, 64512
    s_add_u32 s20, s20, 8192
    s_addc_u32 s21, s21, 0
    global_load_lds_dwordx4 v11, s[20:21] nt
    s_waitcnt vmcnt(0)
    ds_write_b32 v253, v225 offset:84
    s_waitcnt lgkmcnt(0)
    s_endpgm
L_ldshort:
    s_waitcnt vmcnt(0)
    ds_write_b32 v253, v225 offset:76
    s_waitcnt lgkmcnt(0)
    s_endpgm
rt_177:
    s_add_u32 s65, s65, 1
    s_cmp_lt_u32 s65, 40000
    s_cbranch_scc1 lw_176
    s_endpgm
rt_179:
    s_add_u32 s65, s65, 1
    s_cmp_lt_u32 s65, 40000
    s_cbranch_scc1 lw_178
    s_endpgm
rt_271:
    s_add_u32 s65, s65, 1
    s_cmp_lt_u32 s65, 40000
    s_cbranch_scc1 lw_270
    s_endpgm
rt_273:
    s_add_u32 s65, s65, 1
    s_cmp_lt_u32 s65, 40000
    s_cbranch_scc1 lw_272
    s_endpgm
.section .rodata,"a"
.p2align 6
.amdhsa_kernel interleave_layers__sliding_block_cached__mixer_channel_mlp__decode_kernel
  .amdhsa_next_free_vgpr 256
  .amdhsa_next_free_sgpr 102
  .amdhsa_accum_offset 256
  .amdhsa_group_segment_fixed_size 0
  .amdhsa_kernarg_size 104
  .amdhsa_user_sgpr_count 2
  .amdhsa_user_sgpr_kernarg_segment_ptr 1
  .amdhsa_system_sgpr_workgroup_id_x 1
.end_amdhsa_kernel
```
